```python
import torch

def _softmax(x, axis=-1):
    return torch.softmax(x, dim=axis)
def _gelu(x):
    return torch.nn.functional.gelu(x, approximate="tanh")
def _silu(x):
    return torch.nn.functional.silu(x)
def _sigmoid(x):
    return torch.sigmoid(x)
def _layernorm(x, axis=-1, eps=1e-5):
    m = x.mean(dim=axis, keepdim=True)
    v = x.var(dim=axis, keepdim=True, unbiased=False)
    return (x - m) / torch.sqrt(v + eps)
def _scatter_add(tgt, idx, src, axis=0):
    return tgt.clone().index_add_(axis, idx, src)
def _segment_sum(src, seg, n):
    out = torch.zeros((n,) + src.shape[1:], dtype=src.dtype)
    return out.index_add_(0, seg, src)
def _pad(x, pw):
    flat = tuple(v for pair in reversed(pw) for v in pair)
    return torch.nn.functional.pad(x, flat)

kernel_name = 'concat_heads__gqa_block_cached__gqa_block_cached__near_ridge'

def setup_inputs():

    _w = (lambda a: (lambda t: t.to(torch.bfloat16) if t.is_floating_point() else t)(torch.as_tensor(a)))
    def _A_setup():
        B, Sq, D = 8, 64, 448
        Hq, Hkv, Sk, Dh = 16, 8, 64, 256
        assert Hq % Hkv == 0, (Hq, Hkv)
        return {
            "x": _w((lambda *s: torch.randn(*s, dtype=torch.bfloat16) * 0.8)(B, Sq, D)),
            "k_cache": _w((lambda *s: torch.randn(*s, dtype=torch.bfloat16) * 0.8)(B, Hkv, Sk, Dh)),
            "v_cache": _w((lambda *s: torch.randn(*s, dtype=torch.bfloat16) * 0.05)(B, Hkv, Sk, Dh)),
            "wq": _w((lambda *s: torch.randn(*s, dtype=torch.bfloat16) * 0.8)(D, Hq * Dh) * (D ** -0.5)),
            "wo": _w((lambda *s: torch.randn(*s, dtype=torch.bfloat16) * 0.05)(Hq * Dh, D) * ((Hq * Dh) ** -0.5)),
        }
    _A_in = _A_setup()

    def _B_setup():
        B, Sq, D = 8, 64, 448
        Hq, Hkv, Sk, Dh = 16, 8, 64, 256
        assert Hq % Hkv == 0, (Hq, Hkv)
        return {
            "x": _w((lambda *s: torch.randn(*s, dtype=torch.bfloat16) * 0.8)(B, Sq, D)),
            "k_cache": _w((lambda *s: torch.randn(*s, dtype=torch.bfloat16) * 0.8)(B, Hkv, Sk, Dh)),
            "v_cache": _w((lambda *s: torch.randn(*s, dtype=torch.bfloat16) * 0.05)(B, Hkv, Sk, Dh)),
            "wq": _w((lambda *s: torch.randn(*s, dtype=torch.bfloat16) * 0.8)(D, Hq * Dh) * (D ** -0.5)),
            "wo": _w((lambda *s: torch.randn(*s, dtype=torch.bfloat16) * 0.05)(Hq * Dh, D) * ((Hq * Dh) ** -0.5)),
        }
    _B_in = _B_setup()

    return {
        "A_x": _A_in["x"],
        "A_k_cache": _A_in["k_cache"],
        "A_v_cache": _A_in["v_cache"],
        "A_wq": _A_in["wq"],
        "A_wo": _A_in["wo"],
        "B_x": _B_in["x"],
        "B_k_cache": _B_in["k_cache"],
        "B_v_cache": _B_in["v_cache"],
        "B_wq": _B_in["wq"],
        "B_wo": _B_in["wo"],
    }

def reference(A_x, A_k_cache, A_v_cache, A_wq, A_wo, B_x, B_k_cache, B_v_cache, B_wq, B_wo):
    def _A_ref(x, k_cache, v_cache, wq, wo):
        B, Sq, D = x.shape
        Hq, Dh = 16, 256
        Hkv = k_cache.shape[1]
        rep = Hq // Hkv
        q = (lambda x, *d: x.permute(*d))((x @ wq).reshape(B, Sq, Hq, Dh), 0, 2, 1, 3)
        k = (lambda x, n, axis: torch.repeat_interleave(x, n, dim=axis))(k_cache, rep, axis=1)
        v = (lambda x, n, axis: torch.repeat_interleave(x, n, dim=axis))(v_cache, rep, axis=1)
        scores = torch.einsum("bhqd,bhkd->bhqk", q, k) * (Dh ** -0.5)
        p = _softmax(scores, axis=-1)
        o = torch.einsum("bhqk,bhkd->bhqd", p, v)
        return (lambda x, *d: x.permute(*d))(o, 0, 2, 1, 3).reshape(B, Sq, Hq * Dh) @ wo

    def _B_ref(x, k_cache, v_cache, wq, wo):
        B, Sq, D = x.shape
        Hq, Dh = 16, 256
        Hkv = k_cache.shape[1]
        rep = Hq // Hkv
        q = (lambda x, *d: x.permute(*d))((x @ wq).reshape(B, Sq, Hq, Dh), 0, 2, 1, 3)
        k = (lambda x, n, axis: torch.repeat_interleave(x, n, dim=axis))(k_cache, rep, axis=1)
        v = (lambda x, n, axis: torch.repeat_interleave(x, n, dim=axis))(v_cache, rep, axis=1)
        scores = torch.einsum("bhqd,bhkd->bhqk", q, k) * (Dh ** -0.5)
        p = _softmax(scores, axis=-1)
        o = torch.einsum("bhqk,bhkd->bhqd", p, v)
        return (lambda x, *d: x.permute(*d))(o, 0, 2, 1, 3).reshape(B, Sq, Hq * Dh) @ wo

    a = _A_ref(A_x, A_k_cache, A_v_cache, A_wq, A_wo)
    b = _B_ref(B_x, B_k_cache, B_v_cache, B_wq, B_wo)
    return torch.concatenate([a, b], axis=-1)
```

```asm
; @launch grid=(256,1,1) block=(512,1,1) lds=163840
.amdgcn_target "amdgcn-amd-amdhsa--gfx950"
.text
.globl concat_heads__gqa_block_cached__gqa_block_cached__near_ridge_kernel
.p2align 8
.type concat_heads__gqa_block_cached__gqa_block_cached__near_ridge_kernel,@function
concat_heads__gqa_block_cached__gqa_block_cached__near_ridge_kernel:
    s_cmp_ge_u32 s2, 256
    s_cbranch_scc1 L_end
    s_load_dwordx16 s[4:19], s[0:1], 0
    s_load_dwordx4 s[20:23], s[0:1], 64
    s_load_dwordx4 s[24:27], s[0:1], 80
    s_load_dwordx2 s[28:29], s[0:1], 96
    s_and_b32 s74, s2, 7
    s_lshr_b32 s75, s2, 3
    s_lshr_b32 s64, s74, 2
    s_and_b32 s65, s74, 3
    s_lshr_b32 s66, s75, 2
    s_and_b32 s67, s75, 3
    v_lshrrev_b32 v4, 6, v0
    v_and_b32 v0, 63, v0
    v_readfirstlane_b32 s68, v4
    s_lshl_b32 s69, s65, 2
    s_add_u32 s69, s69, s67
    s_lshl_b32 s74, s64, 3
    s_add_u32 s74, s74, s66
    s_lshl_b32 s70, s74, 4
    s_add_u32 s71, s70, s69
    s_lshl_b32 s63, s67, 1
    s_add_u32 s63, s63, s66
    s_lshr_b32 s72, s68, 2
    s_and_b32 s68, s68, 3
    s_cmp_eq_u32 s72, 0
    s_cbranch_scc0 L_cons
L_loader:
    v_lshrrev_b32 v1, 5, v0
    v_and_b32 v2, 31, v0
    v_add_u32 v3, 0, v1
    v_lshlrev_b32 v3, 2, v3
    v_xor_b32 v3, v2, v3
    v_lshlrev_b32 v3, 4, v3
    v_lshlrev_b32 v4, 13, v1
    v_add_u32 v4, v4, v3
    v_add_u32 v3, 2, v1
    v_lshlrev_b32 v3, 2, v3
    v_xor_b32 v3, v2, v3
    v_lshlrev_b32 v3, 4, v3
    v_lshlrev_b32 v5, 13, v1
    v_add_u32 v5, v5, v3
    v_add_u32 v5, 15360, v5
    v_add_u32 v3, 0, v1
    v_lshlrev_b32 v3, 2, v3
    v_xor_b32 v3, v2, v3
    v_lshlrev_b32 v3, 4, v3
    v_lshlrev_b32 v6, 13, v1
    v_add_u32 v6, v6, v3
    v_add_u32 v6, 30720, v6
    v_add_u32 v3, 2, v1
    v_lshlrev_b32 v3, 2, v3
    v_xor_b32 v3, v2, v3
    v_lshlrev_b32 v3, 4, v3
    v_lshlrev_b32 v7, 13, v1
    v_add_u32 v7, v7, v3
    v_add_u32 v7, 46080, v7
    v_lshrrev_b32 v12, 3, v0
    v_and_b32 v13, 7, v0
    v_lshrrev_b32 v14, 4, v0
    v_add_u32 v3, 0, v14
    v_and_b32 v3, 7, v3
    v_xor_b32 v3, v13, v3
    v_lshlrev_b32 v3, 4, v3
    v_add_u32 v15, 0, v12
    v_mul_u32_u24 v8, 896, v15
    v_add_u32 v8, v8, v3
    v_lshlrev_b32 v10, 9, v15
    v_add_u32 v10, v10, v3
    v_add_u32 v3, 4, v14
    v_and_b32 v3, 7, v3
    v_xor_b32 v3, v13, v3
    v_lshlrev_b32 v3, 4, v3
    v_add_u32 v15, 8, v12
    v_mul_u32_u24 v9, 896, v15
    v_add_u32 v9, v9, v3
    v_lshlrev_b32 v11, 9, v15
    v_add_u32 v11, v11, v3
    v_subrev_u32 v9, 1024, v9
    v_subrev_u32 v11, 1024, v11
    s_cmp_ge_u32 s63, 7
    s_cselect_b32 s74, 7, 0
    s_sub_u32 s73, s63, s74
    s_cmp_ge_u32 s73, 7
    s_cselect_b32 s74, 7, 0
    s_sub_u32 s73, s73, s74
    s_lshl_b32 s76, s68, 17
    s_mul_i32 s77, s68, 14336
    s_lshl_b32 s78, s68, 13
    s_lshl_b32 s79, s68, 11
    s_waitcnt lgkmcnt(0)
    s_cmp_eq_u32 s64, 0
    s_cselect_b32 s32, s4, s14
    s_cselect_b32 s33, s5, s15
    s_cselect_b32 s36, s10, s20
    s_cselect_b32 s37, s11, s21
    s_mul_i32 s74, s66, 57344
    s_add_u32 s32, s32, s74
    s_addc_u32 s33, s33, 0
    s_mov_b32 s34, 57344
    s_mov_b32 s35, 0x20000
    s_lshl_b32 s74, s69, 9
    s_add_u32 s36, s36, s74
    s_addc_u32 s37, s37, 0
    s_sub_u32 s38, 3670016, s74
    s_mov_b32 s39, 0x20000
    s_lshl_b32 s74, s73, 19
    s_add_u32 s74, s74, s76
    s_add_u32 m0, s78, 0
    s_add_u32 s75, s74, 65536
    buffer_load_dwordx4 v4, s[36:39], s74 offen offset:0  lds
    buffer_load_dwordx4 v5, s[36:39], s74 offen offset:1024  lds
    buffer_load_dwordx4 v6, s[36:39], s74 offen offset:2048  lds
    buffer_load_dwordx4 v7, s[36:39], s74 offen offset:3072  lds
    s_add_u32 m0, s78, 4096
    s_lshl_b32 s74, s73, 7
    buffer_load_dwordx4 v4, s[36:39], s75 offen offset:0  lds
    buffer_load_dwordx4 v5, s[36:39], s75 offen offset:1024  lds
    buffer_load_dwordx4 v6, s[36:39], s75 offen offset:2048  lds
    buffer_load_dwordx4 v7, s[36:39], s75 offen offset:3072  lds
    s_add_u32 m0, s79, 32768
    s_add_u32 s74, s74, s77
    buffer_load_dwordx4 v8, s[32:35], s74 offen offset:0  lds
    buffer_load_dwordx4 v9, s[32:35], s74 offen offset:1024  lds
    s_add_u32 s73, s73, 1
    s_cmp_eq_u32 s73, 7
    s_cselect_b32 s73, 0, s73
    s_lshl_b32 s74, s73, 19
    s_add_u32 s74, s74, s76
    s_add_u32 m0, s78, 40960
    s_add_u32 s75, s74, 65536
    buffer_load_dwordx4 v4, s[36:39], s74 offen offset:0  lds
    buffer_load_dwordx4 v5, s[36:39], s74 offen offset:1024  lds
    buffer_load_dwordx4 v6, s[36:39], s74 offen offset:2048  lds
    buffer_load_dwordx4 v7, s[36:39], s74 offen offset:3072  lds
    s_add_u32 m0, s78, 45056
    s_lshl_b32 s74, s73, 7
    buffer_load_dwordx4 v4, s[36:39], s75 offen offset:0  lds
    buffer_load_dwordx4 v5, s[36:39], s75 offen offset:1024  lds
    buffer_load_dwordx4 v6, s[36:39], s75 offen offset:2048  lds
    buffer_load_dwordx4 v7, s[36:39], s75 offen offset:3072  lds
    s_add_u32 m0, s79, 73728
    s_add_u32 s74, s74, s77
    buffer_load_dwordx4 v8, s[32:35], s74 offen offset:0  lds
    buffer_load_dwordx4 v9, s[32:35], s74 offen offset:1024  lds
    s_add_u32 s73, s73, 1
    s_cmp_eq_u32 s73, 7
    s_cselect_b32 s73, 0, s73
    s_cmp_eq_u32 s64, 0
    s_cselect_b32 s40, s6, s16
    s_cselect_b32 s41, s7, s17
    s_cselect_b32 s44, s8, s18
    s_cselect_b32 s45, s9, s19
    s_cselect_b32 s48, s12, s22
    s_cselect_b32 s49, s13, s23
    s_lshl_b32 s74, s66, 3
    s_lshr_b32 s75, s69, 1
    s_add_u32 s74, s74, s75
    s_lshl_b32 s74, s74, 15
    s_add_u32 s40, s40, s74
    s_addc_u32 s41, s41, 0
    s_mov_b32 s42, 32768
    s_mov_b32 s43, 0x20000
    s_lshl_b32 s74, s66, 3
    s_lshl_b32 s75, s65, 1
    s_add_u32 s74, s74, s75
    s_lshl_b32 s74, s74, 15
    s_add_u32 s44, s44, s74
    s_addc_u32 s45, s45, 0
    s_mov_b32 s46, 65536
    s_mov_b32 s47, 0x20000
    s_mul_i32 s74, s65, 917504
    s_lshl_b32 s75, s67, 8
    s_add_u32 s74, s74, s75
    s_add_u32 s48, s48, s74
    s_addc_u32 s49, s49, 0
    s_sub_u32 s50, 3670016, s74
    s_mov_b32 s51, 0x20000
    s_mov_b32 s52, s28
    s_mov_b32 s53, s29
    s_mov_b32 s54, 0x10000000
    s_mov_b32 s55, 0x20000
    s_lshl_b32 s74, s68, 2
    v_add_u32 v3, s74, v1
    v_add_u32 v3, 0, v3
    v_xor_b32 v3, v2, v3
    v_lshlrev_b32 v3, 4, v3
    v_lshlrev_b32 v16, 9, v1
    v_add_u32 v16, v16, v3
    v_add_u32 v3, s74, v1
    v_add_u32 v3, 2, v3
    v_xor_b32 v3, v2, v3
    v_lshlrev_b32 v3, 4, v3
    v_lshlrev_b32 v17, 9, v1
    v_add_u32 v17, v17, v3
    v_and_b32 v15, 15, v0
    v_lshlrev_b32 v3, 2, v14
    v_xor_b32 v15, v15, v3
    s_cmp_eq_u32 s67, 3
    s_cselect_b32 s74, 8, 64
    v_cmp_le_u32 vcc, s74, v15
    v_mov_b32 v3, 0x40000000
    s_nop 0
    v_cndmask_b32 v3, 0, v3, vcc
    v_lshlrev_b32 v15, 4, v15
    v_add_u32 v15, v15, v3
    v_mul_u32_u24 v18, 896, v14
    v_add_u32 v18, v18, v15
    v_add_u32 v19, 2560, v18
    v_add_u32 v20, 5120, v18
    v_add_u32 v21, 7680, v18
    v_lshlrev_b32 v22, 4, v0
    s_cmp_eq_u32 s68, 0
    s_cselect_b32 s74, 0, 0x40000000
    v_mov_b32 v24, s74
    v_mov_b32 v3, 0x40000000
    v_cmp_eq_u32 vcc, 0, v0
    s_nop 1
    v_cndmask_b32 v23, v3, v24, vcc
    s_mov_b32 s26, 2097152
    s_lshl_b32 s74, s71, 5
    s_lshl_b32 s75, s68, 2
    s_add_u32 s74, s74, s75
    s_add_u32 s27, s74, 2097168
    v_lshrrev_b32 v3, 2, v0
    v_and_b32 v3, 3, v3
    s_lshl_b32 s74, s65, 2
    s_add_u32 s74, s74, s70
    v_add_u32 v3, s74, v3
    v_lshlrev_b32 v3, 5, v3
    v_and_b32 v26, 3, v0
    v_lshlrev_b32 v26, 2, v26
    v_add_u32 v3, v3, v26
    v_and_b32 v26, 3, v0
    v_lshlrev_b32 v26, 2, v26
    s_add_u32 s74, s70, s67
    v_add_u32 v26, s74, v26
    v_lshlrev_b32 v26, 5, v26
    s_lshl_b32 s74, s65, 2
    s_add_u32 s74, s74, 16
    v_add_u32 v26, s74, v26
    v_cmp_lt_u32 vcc, 15, v0
    s_nop 1
    v_cndmask_b32 v3, v3, v26, vcc
    v_add_u32 v24, v24, v3
    v_mov_b32 v3, 0x40000000
    v_cmp_eq_u32 vcc, 0, v0
    s_nop 1
    v_cndmask_b32 v23, v3, 0, vcc
    s_lshr_b32 s74, s68, 1
    s_lshl_b32 s74, s74, 8
    s_and_b32 s75, s68, 1
    s_lshl_b32 s75, s75, 5
    s_add_u32 s74, s74, s75
    s_mul_i32 s24, s74, 896
    s_and_b32 s25, s63, 7
    s_lshl_b32 s74, s71, 14
    s_lshl_b32 s75, s68, 12
    s_add_u32 s74, s74, s75
    s_add_u32 s74, s74, 2162688
    s_cmp_eq_u32 s68, s65
    s_cselect_b32 s29, 0x40000000, s74
    v_mov_b32 v32, -1
    v_mov_b32 v33, -1
    v_mov_b32 v34, -1
    v_mov_b32 v35, -1
    s_waitcnt vmcnt(10)
    s_barrier
    s_lshl_b32 s74, s73, 19
    s_add_u32 s74, s74, s76
    s_add_u32 m0, s78, 81920
    s_add_u32 s75, s74, 65536
    buffer_load_dwordx4 v4, s[36:39], s74 offen offset:0  lds
    buffer_load_dwordx4 v5, s[36:39], s74 offen offset:1024  lds
    buffer_load_dwordx4 v6, s[36:39], s74 offen offset:2048  lds
    buffer_load_dwordx4 v7, s[36:39], s74 offen offset:3072  lds
    s_add_u32 m0, s78, 86016
    s_lshl_b32 s74, s73, 7
    buffer_load_dwordx4 v4, s[36:39], s75 offen offset:0  lds
    buffer_load_dwordx4 v5, s[36:39], s75 offen offset:1024  lds
    buffer_load_dwordx4 v6, s[36:39], s75 offen offset:2048  lds
    buffer_load_dwordx4 v7, s[36:39], s75 offen offset:3072  lds
    s_add_u32 m0, s79, 114688
    s_add_u32 s74, s74, s77
    buffer_load_dwordx4 v8, s[32:35], s74 offen offset:0  lds
    buffer_load_dwordx4 v9, s[32:35], s74 offen offset:1024  lds
    s_add_u32 s73, s73, 1
    s_cmp_eq_u32 s73, 7
    s_cselect_b32 s73, 0, s73
    s_lshl_b32 s74, s73, 19
    s_add_u32 s74, s74, s76
    s_add_u32 m0, s78, 122880
    s_add_u32 s75, s74, 65536
    buffer_load_dwordx4 v4, s[36:39], s74 offen offset:0  lds
    buffer_load_dwordx4 v5, s[36:39], s74 offen offset:1024  lds
    buffer_load_dwordx4 v6, s[36:39], s74 offen offset:2048  lds
    buffer_load_dwordx4 v7, s[36:39], s74 offen offset:3072  lds
    s_add_u32 m0, s78, 126976
    s_lshl_b32 s74, s73, 7
    buffer_load_dwordx4 v4, s[36:39], s75 offen offset:0  lds
    buffer_load_dwordx4 v5, s[36:39], s75 offen offset:1024  lds
    buffer_load_dwordx4 v6, s[36:39], s75 offen offset:2048  lds
    buffer_load_dwordx4 v7, s[36:39], s75 offen offset:3072  lds
    s_add_u32 m0, s79, 155648
    s_add_u32 s74, s74, s77
    buffer_load_dwordx4 v8, s[32:35], s74 offen offset:0  lds
    buffer_load_dwordx4 v9, s[32:35], s74 offen offset:1024  lds
    s_add_u32 s73, s73, 1
    s_cmp_eq_u32 s73, 7
    s_cselect_b32 s73, 0, s73
    s_waitcnt vmcnt(20)
    s_barrier
    s_add_u32 m0, s78, 0
    s_add_u32 s74, s78, 0
    buffer_load_dwordx4 v16, s[40:43], s74 offen offset:0  lds
    buffer_load_dwordx4 v17, s[40:43], s74 offen offset:1024  lds
    buffer_load_dwordx4 v16, s[40:43], s74 offen offset:2048  lds
    buffer_load_dwordx4 v17, s[40:43], s74 offen offset:3072  lds
    s_add_u32 m0, s78, 4096
    s_add_u32 s74, s78, 4096
    buffer_load_dwordx4 v16, s[40:43], s74 offen offset:0  lds
    buffer_load_dwordx4 v17, s[40:43], s74 offen offset:1024  lds
    buffer_load_dwordx4 v16, s[40:43], s74 offen offset:2048  lds
    buffer_load_dwordx4 v17, s[40:43], s74 offen offset:3072  lds
    s_waitcnt vmcnt(18)
    s_barrier
    s_lshl_b32 s74, s73, 19
    s_add_u32 s74, s74, s76
    s_add_u32 m0, s78, 40960
    s_add_u32 s75, s74, 65536
    buffer_load_dwordx4 v4, s[36:39], s74 offen offset:0  lds
    buffer_load_dwordx4 v5, s[36:39], s74 offen offset:1024  lds
    buffer_load_dwordx4 v6, s[36:39], s74 offen offset:2048  lds
    buffer_load_dwordx4 v7, s[36:39], s74 offen offset:3072  lds
    s_add_u32 m0, s78, 45056
    s_lshl_b32 s74, s73, 7
    buffer_load_dwordx4 v4, s[36:39], s75 offen offset:0  lds
    buffer_load_dwordx4 v5, s[36:39], s75 offen offset:1024  lds
    buffer_load_dwordx4 v6, s[36:39], s75 offen offset:2048  lds
    buffer_load_dwordx4 v7, s[36:39], s75 offen offset:3072  lds
    s_add_u32 m0, s79, 73728
    s_add_u32 s74, s74, s77
    buffer_load_dwordx4 v8, s[32:35], s74 offen offset:0  lds
    buffer_load_dwordx4 v9, s[32:35], s74 offen offset:1024  lds
    s_add_u32 s73, s73, 1
    s_cmp_eq_u32 s73, 7
    s_cselect_b32 s73, 0, s73
    s_waitcnt vmcnt(18)
    s_barrier
    s_lshl_b32 s74, s73, 19
    s_add_u32 s74, s74, s76
    s_add_u32 m0, s78, 81920
    s_add_u32 s75, s74, 65536
    buffer_load_dwordx4 v4, s[36:39], s74 offen offset:0  lds
    buffer_load_dwordx4 v5, s[36:39], s74 offen offset:1024  lds
    buffer_load_dwordx4 v6, s[36:39], s74 offen offset:2048  lds
    buffer_load_dwordx4 v7, s[36:39], s74 offen offset:3072  lds
    s_add_u32 m0, s78, 86016
    s_lshl_b32 s74, s73, 7
    buffer_load_dwordx4 v4, s[36:39], s75 offen offset:0  lds
    buffer_load_dwordx4 v5, s[36:39], s75 offen offset:1024  lds
    buffer_load_dwordx4 v6, s[36:39], s75 offen offset:2048  lds
    buffer_load_dwordx4 v7, s[36:39], s75 offen offset:3072  lds
    s_add_u32 m0, s79, 114688
    s_add_u32 s74, s74, s77
    buffer_load_dwordx4 v8, s[32:35], s74 offen offset:0  lds
    buffer_load_dwordx4 v9, s[32:35], s74 offen offset:1024  lds
    s_add_u32 s73, s73, 1
    s_cmp_eq_u32 s73, 7
    s_cselect_b32 s73, 0, s73
    s_waitcnt vmcnt(10)
    s_barrier
    s_lshl_b32 s74, s73, 19
    s_add_u32 s74, s74, s76
    s_add_u32 m0, s78, 122880
    s_add_u32 s75, s74, 65536
    buffer_load_dwordx4 v4, s[36:39], s74 offen offset:0  lds
    buffer_load_dwordx4 v5, s[36:39], s74 offen offset:1024  lds
    buffer_load_dwordx4 v6, s[36:39], s74 offen offset:2048  lds
    buffer_load_dwordx4 v7, s[36:39], s74 offen offset:3072  lds
    s_add_u32 m0, s78, 126976
    s_lshl_b32 s74, s73, 7
    buffer_load_dwordx4 v4, s[36:39], s75 offen offset:0  lds
    buffer_load_dwordx4 v5, s[36:39], s75 offen offset:1024  lds
    buffer_load_dwordx4 v6, s[36:39], s75 offen offset:2048  lds
    buffer_load_dwordx4 v7, s[36:39], s75 offen offset:3072  lds
    s_add_u32 m0, s79, 155648
    s_add_u32 s74, s74, s77
    buffer_load_dwordx4 v8, s[32:35], s74 offen offset:0  lds
    buffer_load_dwordx4 v9, s[32:35], s74 offen offset:1024  lds
    s_add_u32 s73, s73, 1
    s_cmp_eq_u32 s73, 7
    s_cselect_b32 s73, 0, s73
    s_waitcnt vmcnt(10)
    s_barrier
    s_lshr_b32 s74, s25, 2
    s_xor_b32 s74, s74, 0
    s_add_u32 s75, s25, 0
    s_and_b32 s75, s75, 3
    s_mul_i32 s72, s74, 458752
    s_mul_i32 s73, s75, 57344
    s_add_u32 s72, s72, s73
    s_add_u32 s72, s72, s24
    s_add_u32 m0, s78, 40960
    s_add_u32 s73, s72, 14336
    buffer_load_dwordx4 v18, s[48:51], s72 offen offset:0  lds
    buffer_load_dwordx4 v19, s[48:51], s72 offen offset:1024  lds
    buffer_load_dwordx4 v20, s[48:51], s72 offen offset:2048  lds
    buffer_load_dwordx4 v21, s[48:51], s72 offen offset:3072  lds
    s_add_u32 m0, s78, 45056
    s_lshl_b32 s74, s74, 15
    buffer_load_dwordx4 v18, s[48:51], s73 offen offset:0  lds
    buffer_load_dwordx4 v19, s[48:51], s73 offen offset:1024  lds
    buffer_load_dwordx4 v20, s[48:51], s73 offen offset:2048  lds
    buffer_load_dwordx4 v21, s[48:51], s73 offen offset:3072  lds
    s_lshl_b32 s75, s75, 7
    s_add_u32 s74, s74, s75
    s_add_u32 m0, s79, 73728
    s_add_u32 s74, s74, s78
    buffer_load_dwordx4 v10, s[44:47], s74 offen offset:0  lds
    buffer_load_dwordx4 v11, s[44:47], s74 offen offset:1024  lds
    s_waitcnt vmcnt(10)
    s_barrier
    s_lshr_b32 s74, s25, 2
    s_xor_b32 s74, s74, 0
    s_add_u32 s75, s25, 1
    s_and_b32 s75, s75, 3
    s_mul_i32 s72, s74, 458752
    s_mul_i32 s73, s75, 57344
    s_add_u32 s72, s72, s73
    s_add_u32 s72, s72, s24
    s_add_u32 m0, s78, 0
    s_add_u32 s73, s72, 14336
    buffer_load_dwordx4 v18, s[48:51], s72 offen offset:0  lds
    buffer_load_dwordx4 v19, s[48:51], s72 offen offset:1024  lds
    buffer_load_dwordx4 v20, s[48:51], s72 offen offset:2048  lds
    buffer_load_dwordx4 v21, s[48:51], s72 offen offset:3072  lds
    s_add_u32 m0, s78, 4096
    s_lshl_b32 s74, s74, 15
    buffer_load_dwordx4 v18, s[48:51], s73 offen offset:0  lds
    buffer_load_dwordx4 v19, s[48:51], s73 offen offset:1024  lds
    buffer_load_dwordx4 v20, s[48:51], s73 offen offset:2048  lds
    buffer_load_dwordx4 v21, s[48:51], s73 offen offset:3072  lds
    s_lshl_b32 s75, s75, 7
    s_add_u32 s74, s74, s75
    s_add_u32 m0, s79, 32768
    s_add_u32 s74, s74, s78
    buffer_load_dwordx4 v10, s[44:47], s74 offen offset:0  lds
    buffer_load_dwordx4 v11, s[44:47], s74 offen offset:1024  lds
    s_barrier
    v_mov_b32 v3, 118784
    ds_read_b32 v25, v3
    s_waitcnt lgkmcnt(0)
    v_readfirstlane_b32 s21, v25
    s_lshr_b32 s74, s25, 2
    s_xor_b32 s74, s74, 0
    s_add_u32 s75, s25, 2
    s_and_b32 s75, s75, 3
    s_mul_i32 s72, s74, 458752
    s_mul_i32 s73, s75, 57344
    s_add_u32 s72, s72, s73
    s_add_u32 s72, s72, s24
    s_add_u32 m0, s78, 122880
    s_add_u32 s73, s72, 14336
    buffer_load_dwordx4 v18, s[48:51], s72 offen offset:0  lds
    buffer_load_dwordx4 v19, s[48:51], s72 offen offset:1024  lds
    buffer_load_dwordx4 v20, s[48:51], s72 offen offset:2048  lds
    buffer_load_dwordx4 v21, s[48:51], s72 offen offset:3072  lds
    s_add_u32 m0, s78, 126976
    s_lshl_b32 s74, s74, 15
    buffer_load_dwordx4 v18, s[48:51], s73 offen offset:0  lds
    buffer_load_dwordx4 v19, s[48:51], s73 offen offset:1024  lds
    buffer_load_dwordx4 v20, s[48:51], s73 offen offset:2048  lds
    buffer_load_dwordx4 v21, s[48:51], s73 offen offset:3072  lds
    s_lshl_b32 s75, s75, 7
    s_add_u32 s74, s74, s75
    s_add_u32 m0, s79, 155648
    s_add_u32 s74, s74, s78
    buffer_load_dwordx4 v10, s[44:47], s74 offen offset:0  lds
    buffer_load_dwordx4 v11, s[44:47], s74 offen offset:1024  lds
    buffer_store_dwordx4 v[32:35], v22, s[52:55], s29 offen offset:0 sc1
    buffer_store_dwordx4 v[32:35], v22, s[52:55], s29 offen offset:1024 sc1
    buffer_store_dwordx4 v[32:35], v22, s[52:55], s29 offen offset:2048 sc1
    buffer_store_dwordx4 v[32:35], v22, s[52:55], s29 offen offset:3072 sc1
    s_waitcnt vmcnt(24)
    s_barrier
    s_lshr_b32 s74, s25, 2
    s_xor_b32 s74, s74, 0
    s_add_u32 s75, s25, 3
    s_and_b32 s75, s75, 3
    s_mul_i32 s72, s74, 458752
    s_mul_i32 s73, s75, 57344
    s_add_u32 s72, s72, s73
    s_add_u32 s72, s72, s24
    s_add_u32 m0, s78, 81920
    s_add_u32 s73, s72, 14336
    buffer_load_dwordx4 v18, s[48:51], s72 offen offset:0  lds
    buffer_load_dwordx4 v19, s[48:51], s72 offen offset:1024  lds
    buffer_load_dwordx4 v20, s[48:51], s72 offen offset:2048  lds
    buffer_load_dwordx4 v21, s[48:51], s72 offen offset:3072  lds
    s_add_u32 m0, s78, 86016
    s_lshl_b32 s74, s74, 15
    buffer_load_dwordx4 v18, s[48:51], s73 offen offset:0  lds
    buffer_load_dwordx4 v19, s[48:51], s73 offen offset:1024  lds
    buffer_load_dwordx4 v20, s[48:51], s73 offen offset:2048  lds
    buffer_load_dwordx4 v21, s[48:51], s73 offen offset:3072  lds
    s_lshl_b32 s75, s75, 7
    s_add_u32 s74, s74, s75
    s_add_u32 m0, s79, 114688
    s_add_u32 s74, s74, s78
    buffer_load_dwordx4 v10, s[44:47], s74 offen offset:0  lds
    buffer_load_dwordx4 v11, s[44:47], s74 offen offset:1024  lds
    s_waitcnt vmcnt(10)
    buffer_store_dword v25, v23, s[52:55], s27 offen sc1
    s_barrier
    s_lshr_b32 s74, s25, 2
    s_xor_b32 s74, s74, 1
    s_add_u32 s75, s25, 0
    s_and_b32 s75, s75, 3
    s_mul_i32 s72, s74, 458752
    s_mul_i32 s73, s75, 57344
    s_add_u32 s72, s72, s73
    s_add_u32 s72, s72, s24
    s_add_u32 m0, s78, 40960
    s_add_u32 s73, s72, 14336
    buffer_load_dwordx4 v18, s[48:51], s72 offen offset:0  lds
    buffer_load_dwordx4 v19, s[48:51], s72 offen offset:1024  lds
    buffer_load_dwordx4 v20, s[48:51], s72 offen offset:2048  lds
    buffer_load_dwordx4 v21, s[48:51], s72 offen offset:3072  lds
    s_add_u32 m0, s78, 45056
    s_lshl_b32 s74, s74, 15
    buffer_load_dwordx4 v18, s[48:51], s73 offen offset:0  lds
    buffer_load_dwordx4 v19, s[48:51], s73 offen offset:1024  lds
    buffer_load_dwordx4 v20, s[48:51], s73 offen offset:2048  lds
    buffer_load_dwordx4 v21, s[48:51], s73 offen offset:3072  lds
    s_lshl_b32 s75, s75, 7
    s_add_u32 s74, s74, s75
    s_add_u32 m0, s79, 73728
    s_add_u32 s74, s74, s78
    buffer_load_dwordx4 v10, s[44:47], s74 offen offset:0  lds
    buffer_load_dwordx4 v11, s[44:47], s74 offen offset:1024  lds
    s_barrier
    s_lshr_b32 s74, s25, 2
    s_xor_b32 s74, s74, 1
    s_add_u32 s75, s25, 1
    s_and_b32 s75, s75, 3
    s_mul_i32 s72, s74, 458752
    s_mul_i32 s73, s75, 57344
    s_add_u32 s72, s72, s73
    s_add_u32 s72, s72, s24
    s_add_u32 m0, s78, 0
    s_add_u32 s73, s72, 14336
    buffer_load_dwordx4 v18, s[48:51], s72 offen offset:0  lds
    buffer_load_dwordx4 v19, s[48:51], s72 offen offset:1024  lds
    buffer_load_dwordx4 v20, s[48:51], s72 offen offset:2048  lds
    buffer_load_dwordx4 v21, s[48:51], s72 offen offset:3072  lds
    s_add_u32 m0, s78, 4096
    s_lshl_b32 s74, s74, 15
    buffer_load_dwordx4 v18, s[48:51], s73 offen offset:0  lds
    buffer_load_dwordx4 v19, s[48:51], s73 offen offset:1024  lds
    buffer_load_dwordx4 v20, s[48:51], s73 offen offset:2048  lds
    buffer_load_dwordx4 v21, s[48:51], s73 offen offset:3072  lds
    s_lshl_b32 s75, s75, 7
    s_add_u32 s74, s74, s75
    s_add_u32 m0, s79, 32768
    s_add_u32 s74, s74, s78
    buffer_load_dwordx4 v10, s[44:47], s74 offen offset:0  lds
    buffer_load_dwordx4 v11, s[44:47], s74 offen offset:1024  lds
    s_waitcnt vmcnt(21)
    s_barrier
    s_lshr_b32 s74, s25, 2
    s_xor_b32 s74, s74, 1
    s_add_u32 s75, s25, 2
    s_and_b32 s75, s75, 3
    s_mul_i32 s72, s74, 458752
    s_mul_i32 s73, s75, 57344
    s_add_u32 s72, s72, s73
    s_add_u32 s72, s72, s24
    s_add_u32 m0, s78, 122880
    s_add_u32 s73, s72, 14336
    buffer_load_dwordx4 v18, s[48:51], s72 offen offset:0  lds
    buffer_load_dwordx4 v19, s[48:51], s72 offen offset:1024  lds
    buffer_load_dwordx4 v20, s[48:51], s72 offen offset:2048  lds
    buffer_load_dwordx4 v21, s[48:51], s72 offen offset:3072  lds
    s_add_u32 m0, s78, 126976
    s_lshl_b32 s74, s74, 15
    buffer_load_dwordx4 v18, s[48:51], s73 offen offset:0  lds
    buffer_load_dwordx4 v19, s[48:51], s73 offen offset:1024  lds
    buffer_load_dwordx4 v20, s[48:51], s73 offen offset:2048  lds
    buffer_load_dwordx4 v21, s[48:51], s73 offen offset:3072  lds
    s_lshl_b32 s75, s75, 7
    s_add_u32 s74, s74, s75
    s_add_u32 m0, s79, 155648
    s_add_u32 s74, s74, s78
    buffer_load_dwordx4 v10, s[44:47], s74 offen offset:0  lds
    buffer_load_dwordx4 v11, s[44:47], s74 offen offset:1024  lds
    s_waitcnt vmcnt(20)
    s_barrier
    buffer_load_dword v28, v24, s[52:55], s26 offen sc1
    s_lshr_b32 s74, s25, 2
    s_xor_b32 s74, s74, 1
    s_add_u32 s75, s25, 3
    s_and_b32 s75, s75, 3
    s_mul_i32 s72, s74, 458752
    s_mul_i32 s73, s75, 57344
    s_add_u32 s72, s72, s73
    s_add_u32 s72, s72, s24
    s_add_u32 m0, s78, 81920
    s_add_u32 s73, s72, 14336
    buffer_load_dwordx4 v18, s[48:51], s72 offen offset:0  lds
    buffer_load_dwordx4 v19, s[48:51], s72 offen offset:1024  lds
    buffer_load_dwordx4 v20, s[48:51], s72 offen offset:2048  lds
    buffer_load_dwordx4 v21, s[48:51], s72 offen offset:3072  lds
    s_add_u32 m0, s78, 86016
    s_lshl_b32 s74, s74, 15
    buffer_load_dwordx4 v18, s[48:51], s73 offen offset:0  lds
    buffer_load_dwordx4 v19, s[48:51], s73 offen offset:1024  lds
    buffer_load_dwordx4 v20, s[48:51], s73 offen offset:2048  lds
    buffer_load_dwordx4 v21, s[48:51], s73 offen offset:3072  lds
    s_lshl_b32 s75, s75, 7
    s_add_u32 s74, s74, s75
    s_add_u32 m0, s79, 114688
    s_add_u32 s74, s74, s78
    buffer_load_dwordx4 v10, s[44:47], s74 offen offset:0  lds
    buffer_load_dwordx4 v11, s[44:47], s74 offen offset:1024  lds
    s_waitcnt vmcnt(21)
    s_barrier
    s_waitcnt vmcnt(11)
    s_waitcnt vmcnt(10)
    s_cmp_lg_u32 s68, 0
    s_cbranch_scc1 L_p1ok_2
    s_mov_b32 s28, 0x40000
L_p1_1:
    v_cmp_ne_u32 vcc, s21, v28
    s_nop 4
    s_cbranch_vccz L_p1ok_2
    s_sub_u32 s28, s28, 1
    s_cbranch_scc1 L_p1ok_2
    buffer_load_dword v28, v24, s[52:55], s26 offen sc1
    s_waitcnt vmcnt(0)
    s_branch L_p1_1
L_p1ok_2:
    s_barrier
    s_lshl_b32 s74, s65, 2
    s_add_u32 s74, s74, s70
    s_add_u32 s74, s74, s68
    s_lshl_b32 s74, s74, 13
    s_add_u32 m0, s78, 40960
    s_add_u32 s75, s74, 0
    buffer_load_dwordx4 v22, s[52:55], s75 offen offset:0 sc1 lds
    buffer_load_dwordx4 v22, s[52:55], s75 offen offset:1024 sc1 lds
    buffer_load_dwordx4 v22, s[52:55], s75 offen offset:2048 sc1 lds
    buffer_load_dwordx4 v22, s[52:55], s75 offen offset:3072 sc1 lds
    s_add_u32 m0, s78, 45056
    s_add_u32 s75, s74, 4096
    buffer_load_dwordx4 v22, s[52:55], s75 offen offset:0 sc1 lds
    buffer_load_dwordx4 v22, s[52:55], s75 offen offset:1024 sc1 lds
    buffer_load_dwordx4 v22, s[52:55], s75 offen offset:2048 sc1 lds
    buffer_load_dwordx4 v22, s[52:55], s75 offen offset:3072 sc1 lds
    s_waitcnt vmcnt(8)
    s_barrier
    s_waitcnt vmcnt(0)
    s_barrier
L_end:
    s_endpgm
L_cons:
    s_setprio 1
    v_lshrrev_b32 v1, 5, v0
    v_bfe_u32 v2, v0, 4, 1
    v_bfe_u32 v3, v0, 2, 2
    v_and_b32 v4, 3, v0
    v_and_b32 v5, 1, v4
    v_lshlrev_b32 v5, 2, v5
    v_lshlrev_b32 v6, 1, v2
    v_add_u32 v5, v5, v6
    v_lshrrev_b32 v6, 1, v4
    v_add_u32 v5, v5, v6
    v_lshlrev_b32 v5, 3, v5
    v_lshlrev_b32 v6, 3, v1
    v_add_u32 v6, v6, v3
    s_lshl_b32 s74, s68, 1
    v_xor_b32 v7, s74, v3
    v_lshlrev_b32 v7, 6, v7
    v_lshlrev_b32 v8, 9, v6
    v_add3_u32 v8, v8, v7, v5
    v_xor_b32 v9, 64, v8
    v_xor_b32 v7, s68, v3
    v_lshlrev_b32 v7, 6, v7
    v_lshlrev_b32 v10, 8, v6
    v_add3_u32 v10, v10, v7, v5
    v_and_b32 v7, 31, v0
    v_bfe_u32 v11, v0, 1, 3
    v_xor_b32 v11, v11, v1
    v_lshlrev_b32 v11, 4, v11
    v_lshlrev_b32 v12, 7, v7
    v_add_u32 v12, v12, v11
    v_add_u32 v12, 32768, v12
    v_xor_b32 v13, 32, v12
    v_xor_b32 v14, 64, v12
    v_xor_b32 v15, 96, v12
    v_bfe_u32 v11, v0, 2, 1
    v_lshlrev_b32 v11, 4, v11
    v_bfe_u32 v16, v0, 3, 2
    v_lshlrev_b32 v16, 2, v16
    v_add3_u32 v11, v11, v16, v4
    v_bfe_u32 v16, v11, 1, 3
    v_xor_b32 v16, v16, v1
    v_lshlrev_b32 v16, 4, v16
    v_lshlrev_b32 v11, 7, v11
    v_add_u32 v16, v16, v11
    v_add_u32 v16, 32768, v16
    v_xor_b32 v17, 32, v16
    v_xor_b32 v18, 64, v16
    v_xor_b32 v19, 96, v16
    v_add_u32 v10, 40960, v10
    v_add_u32 v16, 40960, v16
    v_add_u32 v17, 40960, v17
    v_add_u32 v18, 40960, v18
    v_add_u32 v19, 40960, v19
    s_and_b32 s74, s68, 1
    s_lshl_b32 s74, s74, 3
    v_lshlrev_b32 v11, 1, v1
    v_add_u32 v11, s74, v11
    v_and_b32 v20, 15, v0
    v_xor_b32 v11, v11, v20
    v_lshlrev_b32 v11, 4, v11
    v_lshlrev_b32 v20, 9, v7
    v_add_u32 v20, v20, v11
    s_lshr_b32 s74, s68, 1
    s_lshl_b32 s74, s74, 8
    s_add_u32 s74, s74, 81920
    v_add_u32 v20, s74, v20
    v_and_b32 v21, 15, v0
    v_lshrrev_b32 v22, 4, v0
    v_xor_b32 v11, v21, v22
    v_lshlrev_b32 v11, 4, v11
    v_lshlrev_b32 v24, 9, v21
    v_add_u32 v24, v24, v11
    s_lshl_b32 s74, s68, 13
    s_add_u32 s74, s74, 81920
    v_add_u32 v24, s74, v24
    v_xor_b32 v25, 64, v24
    v_xor_b32 v26, 128, v24
    v_xor_b32 v27, 192, v24
    v_lshrrev_b32 v28, 2, v21
    v_lshlrev_b32 v28, 4, v28
    v_and_b32 v23, 3, v21
    v_add_u32 v28, v28, v23
    v_lshlrev_b32 v28, 9, v28
    v_add_u32 v28, v28, v11
    v_xor_b32 v29, 64, v28
    v_xor_b32 v30, 128, v28
    v_xor_b32 v31, 192, v28
    s_waitcnt lgkmcnt(0)
    s_mov_b32 s52, s28
    s_mov_b32 s53, s29
    s_mov_b32 s54, 0x10000000
    s_mov_b32 s55, 0x20000
    s_mul_i32 s74, s66, 114688
    s_add_u32 s56, s24, s74
    s_addc_u32 s57, s25, 0
    s_sub_u32 s58, 917504, s74
    s_mov_b32 s59, 0x20000
    s_mov_b32 s20, 0x3db8aa3b
    s_lshl_b32 s74, s70, 3
    s_add_u32 s74, s74, 2129920
    v_mov_b32 v1, 0
    buffer_load_dword v2, v1, s[52:55], s74 offen sc1
    s_barrier
    ds_read_b64_tr_b16 v[32:33], v8 offset:0
    ds_read_b64_tr_b16 v[34:35], v8 offset:2048
    ds_read_b64_tr_b16 v[36:37], v9 offset:0
    ds_read_b64_tr_b16 v[38:39], v9 offset:2048
    ds_read_b128 v[40:43], v12 offset:0
    ds_read_b128 v[44:47], v12 offset:4096
    ds_read_b64_tr_b16 v[48:49], v8 offset:8192
    ds_read_b64_tr_b16 v[50:51], v8 offset:10240
    ds_read_b64_tr_b16 v[52:53], v9 offset:8192
    ds_read_b64_tr_b16 v[54:55], v9 offset:10240
    ds_read_b128 v[56:59], v13 offset:0
    ds_read_b128 v[60:63], v13 offset:4096
    s_waitcnt lgkmcnt(6)
    v_mfma_f32_32x32x16_bf16 v[64:79], v[32:35], v[40:43], 0
    v_mfma_f32_32x32x16_bf16 v[80:95], v[32:35], v[44:47], 0
    v_mfma_f32_32x32x16_bf16 v[96:111], v[36:39], v[40:43], 0
    v_mfma_f32_32x32x16_bf16 v[112:127], v[36:39], v[44:47], 0
    ds_read_b64_tr_b16 v[32:33], v8 offset:16384
    ds_read_b64_tr_b16 v[34:35], v8 offset:18432
    ds_read_b64_tr_b16 v[36:37], v9 offset:16384
    ds_read_b64_tr_b16 v[38:39], v9 offset:18432
    ds_read_b128 v[40:43], v14 offset:0
    ds_read_b128 v[44:47], v14 offset:4096
    s_waitcnt lgkmcnt(6)
    v_mfma_f32_32x32x16_bf16 v[64:79], v[48:51], v[56:59], v[64:79]
    v_mfma_f32_32x32x16_bf16 v[80:95], v[48:51], v[60:63], v[80:95]
    v_mfma_f32_32x32x16_bf16 v[96:111], v[52:55], v[56:59], v[96:111]
    v_mfma_f32_32x32x16_bf16 v[112:127], v[52:55], v[60:63], v[112:127]
    ds_read_b64_tr_b16 v[48:49], v8 offset:24576
    ds_read_b64_tr_b16 v[50:51], v8 offset:26624
    ds_read_b64_tr_b16 v[52:53], v9 offset:24576
    ds_read_b64_tr_b16 v[54:55], v9 offset:26624
    ds_read_b128 v[56:59], v15 offset:0
    ds_read_b128 v[60:63], v15 offset:4096
    v_add_u32 v8, 40960, v8
    v_add_u32 v9, 40960, v9
    v_add_u32 v12, 40960, v12
    v_add_u32 v13, 40960, v13
    v_add_u32 v14, 40960, v14
    v_add_u32 v15, 40960, v15
    s_waitcnt lgkmcnt(6)
    v_mfma_f32_32x32x16_bf16 v[64:79], v[32:35], v[40:43], v[64:79]
    v_mfma_f32_32x32x16_bf16 v[80:95], v[32:35], v[44:47], v[80:95]
    v_mfma_f32_32x32x16_bf16 v[96:111], v[36:39], v[40:43], v[96:111]
    v_mfma_f32_32x32x16_bf16 v[112:127], v[36:39], v[44:47], v[112:127]
    s_waitcnt lgkmcnt(0)
    s_barrier
    ds_read_b64_tr_b16 v[32:33], v8 offset:0
    ds_read_b64_tr_b16 v[34:35], v8 offset:2048
    ds_read_b64_tr_b16 v[36:37], v9 offset:0
    ds_read_b64_tr_b16 v[38:39], v9 offset:2048
    ds_read_b128 v[40:43], v12 offset:0
    ds_read_b128 v[44:47], v12 offset:4096
    v_mfma_f32_32x32x16_bf16 v[64:79], v[48:51], v[56:59], v[64:79]
    v_mfma_f32_32x32x16_bf16 v[80:95], v[48:51], v[60:63], v[80:95]
    v_mfma_f32_32x32x16_bf16 v[96:111], v[52:55], v[56:59], v[96:111]
    v_mfma_f32_32x32x16_bf16 v[112:127], v[52:55], v[60:63], v[112:127]
    ds_read_b64_tr_b16 v[48:49], v8 offset:8192
    ds_read_b64_tr_b16 v[50:51], v8 offset:10240
    ds_read_b64_tr_b16 v[52:53], v9 offset:8192
    ds_read_b64_tr_b16 v[54:55], v9 offset:10240
    ds_read_b128 v[56:59], v13 offset:0
    ds_read_b128 v[60:63], v13 offset:4096
    s_waitcnt lgkmcnt(6)
    v_mfma_f32_32x32x16_bf16 v[64:79], v[32:35], v[40:43], v[64:79]
    v_mfma_f32_32x32x16_bf16 v[80:95], v[32:35], v[44:47], v[80:95]
    v_mfma_f32_32x32x16_bf16 v[96:111], v[36:39], v[40:43], v[96:111]
    v_mfma_f32_32x32x16_bf16 v[112:127], v[36:39], v[44:47], v[112:127]
    ds_read_b64_tr_b16 v[32:33], v8 offset:16384
    ds_read_b64_tr_b16 v[34:35], v8 offset:18432
    ds_read_b64_tr_b16 v[36:37], v9 offset:16384
    ds_read_b64_tr_b16 v[38:39], v9 offset:18432
    ds_read_b128 v[40:43], v14 offset:0
    ds_read_b128 v[44:47], v14 offset:4096
    s_waitcnt lgkmcnt(6)
    v_mfma_f32_32x32x16_bf16 v[64:79], v[48:51], v[56:59], v[64:79]
    v_mfma_f32_32x32x16_bf16 v[80:95], v[48:51], v[60:63], v[80:95]
    v_mfma_f32_32x32x16_bf16 v[96:111], v[52:55], v[56:59], v[96:111]
    v_mfma_f32_32x32x16_bf16 v[112:127], v[52:55], v[60:63], v[112:127]
    ds_read_b64_tr_b16 v[48:49], v8 offset:24576
    ds_read_b64_tr_b16 v[50:51], v8 offset:26624
    ds_read_b64_tr_b16 v[52:53], v9 offset:24576
    ds_read_b64_tr_b16 v[54:55], v9 offset:26624
    ds_read_b128 v[56:59], v15 offset:0
    ds_read_b128 v[60:63], v15 offset:4096
    v_add_u32 v8, 40960, v8
    v_add_u32 v9, 40960, v9
    v_add_u32 v12, 40960, v12
    v_add_u32 v13, 40960, v13
    v_add_u32 v14, 40960, v14
    v_add_u32 v15, 40960, v15
    s_waitcnt lgkmcnt(6)
    v_mfma_f32_32x32x16_bf16 v[64:79], v[32:35], v[40:43], v[64:79]
    v_mfma_f32_32x32x16_bf16 v[80:95], v[32:35], v[44:47], v[80:95]
    v_mfma_f32_32x32x16_bf16 v[96:111], v[36:39], v[40:43], v[96:111]
    v_mfma_f32_32x32x16_bf16 v[112:127], v[36:39], v[44:47], v[112:127]
    s_waitcnt lgkmcnt(0)
    s_barrier
    ds_read_b64_tr_b16 v[32:33], v8 offset:0
    ds_read_b64_tr_b16 v[34:35], v8 offset:2048
    ds_read_b64_tr_b16 v[36:37], v9 offset:0
    ds_read_b64_tr_b16 v[38:39], v9 offset:2048
    ds_read_b128 v[40:43], v12 offset:0
    ds_read_b128 v[44:47], v12 offset:4096
    v_mfma_f32_32x32x16_bf16 v[64:79], v[48:51], v[56:59], v[64:79]
    v_mfma_f32_32x32x16_bf16 v[80:95], v[48:51], v[60:63], v[80:95]
    v_mfma_f32_32x32x16_bf16 v[96:111], v[52:55], v[56:59], v[96:111]
    v_mfma_f32_32x32x16_bf16 v[112:127], v[52:55], v[60:63], v[112:127]
    ds_read_b64_tr_b16 v[48:49], v8 offset:8192
    ds_read_b64_tr_b16 v[50:51], v8 offset:10240
    ds_read_b64_tr_b16 v[52:53], v9 offset:8192
    ds_read_b64_tr_b16 v[54:55], v9 offset:10240
    ds_read_b128 v[56:59], v13 offset:0
    ds_read_b128 v[60:63], v13 offset:4096
    s_waitcnt lgkmcnt(6)
    v_mfma_f32_32x32x16_bf16 v[64:79], v[32:35], v[40:43], v[64:79]
    v_mfma_f32_32x32x16_bf16 v[80:95], v[32:35], v[44:47], v[80:95]
    v_mfma_f32_32x32x16_bf16 v[96:111], v[36:39], v[40:43], v[96:111]
    v_mfma_f32_32x32x16_bf16 v[112:127], v[36:39], v[44:47], v[112:127]
    ds_read_b64_tr_b16 v[32:33], v8 offset:16384
    ds_read_b64_tr_b16 v[34:35], v8 offset:18432
    ds_read_b64_tr_b16 v[36:37], v9 offset:16384
    ds_read_b64_tr_b16 v[38:39], v9 offset:18432
    ds_read_b128 v[40:43], v14 offset:0
    ds_read_b128 v[44:47], v14 offset:4096
    s_waitcnt lgkmcnt(6)
    v_mfma_f32_32x32x16_bf16 v[64:79], v[48:51], v[56:59], v[64:79]
    v_mfma_f32_32x32x16_bf16 v[80:95], v[48:51], v[60:63], v[80:95]
    v_mfma_f32_32x32x16_bf16 v[96:111], v[52:55], v[56:59], v[96:111]
    v_mfma_f32_32x32x16_bf16 v[112:127], v[52:55], v[60:63], v[112:127]
    ds_read_b64_tr_b16 v[48:49], v8 offset:24576
    ds_read_b64_tr_b16 v[50:51], v8 offset:26624
    ds_read_b64_tr_b16 v[52:53], v9 offset:24576
    ds_read_b64_tr_b16 v[54:55], v9 offset:26624
    ds_read_b128 v[56:59], v15 offset:0
    ds_read_b128 v[60:63], v15 offset:4096
    v_add_u32 v8, 40960, v8
    v_add_u32 v9, 40960, v9
    v_add_u32 v12, 40960, v12
    v_add_u32 v13, 40960, v13
    v_add_u32 v14, 40960, v14
    v_add_u32 v15, 40960, v15
    s_waitcnt lgkmcnt(6)
    v_mfma_f32_32x32x16_bf16 v[64:79], v[32:35], v[40:43], v[64:79]
    v_mfma_f32_32x32x16_bf16 v[80:95], v[32:35], v[44:47], v[80:95]
    v_mfma_f32_32x32x16_bf16 v[96:111], v[36:39], v[40:43], v[96:111]
    v_mfma_f32_32x32x16_bf16 v[112:127], v[36:39], v[44:47], v[112:127]
    s_waitcnt lgkmcnt(0)
    s_barrier
    ds_read_b64_tr_b16 v[32:33], v8 offset:0
    ds_read_b64_tr_b16 v[34:35], v8 offset:2048
    ds_read_b64_tr_b16 v[36:37], v9 offset:0
    ds_read_b64_tr_b16 v[38:39], v9 offset:2048
    ds_read_b128 v[40:43], v12 offset:0
    ds_read_b128 v[44:47], v12 offset:4096
    v_mfma_f32_32x32x16_bf16 v[64:79], v[48:51], v[56:59], v[64:79]
    v_mfma_f32_32x32x16_bf16 v[80:95], v[48:51], v[60:63], v[80:95]
    v_mfma_f32_32x32x16_bf16 v[96:111], v[52:55], v[56:59], v[96:111]
    v_mfma_f32_32x32x16_bf16 v[112:127], v[52:55], v[60:63], v[112:127]
    ds_read_b64_tr_b16 v[48:49], v8 offset:8192
    ds_read_b64_tr_b16 v[50:51], v8 offset:10240
    ds_read_b64_tr_b16 v[52:53], v9 offset:8192
    ds_read_b64_tr_b16 v[54:55], v9 offset:10240
    ds_read_b128 v[56:59], v13 offset:0
    ds_read_b128 v[60:63], v13 offset:4096
    s_waitcnt lgkmcnt(6)
    v_mfma_f32_32x32x16_bf16 v[64:79], v[32:35], v[40:43], v[64:79]
    v_mfma_f32_32x32x16_bf16 v[80:95], v[32:35], v[44:47], v[80:95]
    v_mfma_f32_32x32x16_bf16 v[96:111], v[36:39], v[40:43], v[96:111]
    v_mfma_f32_32x32x16_bf16 v[112:127], v[36:39], v[44:47], v[112:127]
    ds_read_b64_tr_b16 v[32:33], v8 offset:16384
    ds_read_b64_tr_b16 v[34:35], v8 offset:18432
    ds_read_b64_tr_b16 v[36:37], v9 offset:16384
    ds_read_b64_tr_b16 v[38:39], v9 offset:18432
    ds_read_b128 v[40:43], v14 offset:0
    ds_read_b128 v[44:47], v14 offset:4096
    s_waitcnt lgkmcnt(6)
    v_mfma_f32_32x32x16_bf16 v[64:79], v[48:51], v[56:59], v[64:79]
    v_mfma_f32_32x32x16_bf16 v[80:95], v[48:51], v[60:63], v[80:95]
    v_mfma_f32_32x32x16_bf16 v[96:111], v[52:55], v[56:59], v[96:111]
    v_mfma_f32_32x32x16_bf16 v[112:127], v[52:55], v[60:63], v[112:127]
    ds_read_b64_tr_b16 v[48:49], v8 offset:24576
    ds_read_b64_tr_b16 v[50:51], v8 offset:26624
    ds_read_b64_tr_b16 v[52:53], v9 offset:24576
    ds_read_b64_tr_b16 v[54:55], v9 offset:26624
    ds_read_b128 v[56:59], v15 offset:0
    ds_read_b128 v[60:63], v15 offset:4096
    v_subrev_u32 v8, 81920, v8
    v_subrev_u32 v9, 81920, v9
    v_subrev_u32 v12, 81920, v12
    v_subrev_u32 v13, 81920, v13
    v_subrev_u32 v14, 81920, v14
    v_subrev_u32 v15, 81920, v15
    s_waitcnt lgkmcnt(6)
    v_mfma_f32_32x32x16_bf16 v[64:79], v[32:35], v[40:43], v[64:79]
    v_mfma_f32_32x32x16_bf16 v[80:95], v[32:35], v[44:47], v[80:95]
    v_mfma_f32_32x32x16_bf16 v[96:111], v[36:39], v[40:43], v[96:111]
    v_mfma_f32_32x32x16_bf16 v[112:127], v[36:39], v[44:47], v[112:127]
    s_waitcnt lgkmcnt(0)
    s_waitcnt vmcnt(0)
    v_readfirstlane_b32 s21, v2
    s_nop 1
    s_add_u32 s21, s21, 1
    s_barrier
    ds_read_b64_tr_b16 v[32:33], v8 offset:0
    ds_read_b64_tr_b16 v[34:35], v8 offset:2048
    ds_read_b64_tr_b16 v[36:37], v9 offset:0
    ds_read_b64_tr_b16 v[38:39], v9 offset:2048
    ds_read_b128 v[40:43], v12 offset:0
    ds_read_b128 v[44:47], v12 offset:4096
    v_mfma_f32_32x32x16_bf16 v[64:79], v[48:51], v[56:59], v[64:79]
    ds_read_b128 v[128:131], v28 offset:0
    v_mfma_f32_32x32x16_bf16 v[80:95], v[48:51], v[60:63], v[80:95]
    ds_read_b128 v[132:135], v28 offset:2048
    v_mfma_f32_32x32x16_bf16 v[96:111], v[52:55], v[56:59], v[96:111]
    ds_read_b128 v[136:139], v28 offset:4096
    v_mfma_f32_32x32x16_bf16 v[112:127], v[52:55], v[60:63], v[112:127]
    ds_read_b128 v[140:143], v28 offset:6144
    ds_read_b64_tr_b16 v[48:49], v8 offset:8192
    ds_read_b64_tr_b16 v[50:51], v8 offset:10240
    ds_read_b64_tr_b16 v[52:53], v9 offset:8192
    ds_read_b64_tr_b16 v[54:55], v9 offset:10240
    ds_read_b128 v[56:59], v13 offset:0
    ds_read_b128 v[60:63], v13 offset:4096
    s_waitcnt lgkmcnt(10)
    v_mfma_f32_32x32x16_bf16 v[64:79], v[32:35], v[40:43], v[64:79]
    ds_read_b128 v[144:147], v29 offset:0
    v_mfma_f32_32x32x16_bf16 v[80:95], v[32:35], v[44:47], v[80:95]
    ds_read_b128 v[148:151], v29 offset:2048
    v_mfma_f32_32x32x16_bf16 v[96:111], v[36:39], v[40:43], v[96:111]
    ds_read_b128 v[152:155], v29 offset:4096
    v_mfma_f32_32x32x16_bf16 v[112:127], v[36:39], v[44:47], v[112:127]
    ds_read_b128 v[156:159], v29 offset:6144
    ds_read_b64_tr_b16 v[32:33], v8 offset:16384
    ds_read_b64_tr_b16 v[34:35], v8 offset:18432
    ds_read_b64_tr_b16 v[36:37], v9 offset:16384
    ds_read_b64_tr_b16 v[38:39], v9 offset:18432
    ds_read_b128 v[40:43], v14 offset:0
    ds_read_b128 v[44:47], v14 offset:4096
    s_waitcnt lgkmcnt(10)
    v_mfma_f32_32x32x16_bf16 v[64:79], v[48:51], v[56:59], v[64:79]
    ds_read_b128 v[160:163], v30 offset:0
    v_mfma_f32_32x32x16_bf16 v[80:95], v[48:51], v[60:63], v[80:95]
    ds_read_b128 v[164:167], v30 offset:2048
    v_mfma_f32_32x32x16_bf16 v[96:111], v[52:55], v[56:59], v[96:111]
    ds_read_b128 v[168:171], v30 offset:4096
    v_mfma_f32_32x32x16_bf16 v[112:127], v[52:55], v[60:63], v[112:127]
    ds_read_b128 v[172:175], v30 offset:6144
    ds_read_b64_tr_b16 v[48:49], v8 offset:24576
    ds_read_b64_tr_b16 v[50:51], v8 offset:26624
    ds_read_b64_tr_b16 v[52:53], v9 offset:24576
    ds_read_b64_tr_b16 v[54:55], v9 offset:26624
    ds_read_b128 v[56:59], v15 offset:0
    ds_read_b128 v[60:63], v15 offset:4096
    v_add_u32 v8, 40960, v8
    v_add_u32 v9, 40960, v9
    v_add_u32 v12, 40960, v12
    v_add_u32 v13, 40960, v13
    v_add_u32 v14, 40960, v14
    v_add_u32 v15, 40960, v15
    s_waitcnt lgkmcnt(10)
    v_mfma_f32_32x32x16_bf16 v[64:79], v[32:35], v[40:43], v[64:79]
    ds_read_b128 v[176:179], v31 offset:0
    v_mfma_f32_32x32x16_bf16 v[80:95], v[32:35], v[44:47], v[80:95]
    ds_read_b128 v[180:183], v31 offset:2048
    v_mfma_f32_32x32x16_bf16 v[96:111], v[36:39], v[40:43], v[96:111]
    ds_read_b128 v[184:187], v31 offset:4096
    v_mfma_f32_32x32x16_bf16 v[112:127], v[36:39], v[44:47], v[112:127]
    ds_read_b128 v[188:191], v31 offset:6144
    s_waitcnt lgkmcnt(4)
    s_barrier
    ds_read_b64_tr_b16 v[32:33], v8 offset:0
    ds_read_b64_tr_b16 v[34:35], v8 offset:2048
    ds_read_b64_tr_b16 v[36:37], v9 offset:0
    ds_read_b64_tr_b16 v[38:39], v9 offset:2048
    ds_read_b128 v[40:43], v12 offset:0
    ds_read_b128 v[44:47], v12 offset:4096
    v_mfma_f32_32x32x16_bf16 v[64:79], v[48:51], v[56:59], v[64:79]
    ds_read_b128 v[192:195], v28 offset:256
    v_mfma_f32_32x32x16_bf16 v[80:95], v[48:51], v[60:63], v[80:95]
    ds_read_b128 v[196:199], v28 offset:2304
    v_mfma_f32_32x32x16_bf16 v[96:111], v[52:55], v[56:59], v[96:111]
    ds_read_b128 v[200:203], v28 offset:4352
    v_mfma_f32_32x32x16_bf16 v[112:127], v[52:55], v[60:63], v[112:127]
    ds_read_b128 v[204:207], v28 offset:6400
    ds_read_b64_tr_b16 v[48:49], v8 offset:8192
    ds_read_b64_tr_b16 v[50:51], v8 offset:10240
    ds_read_b64_tr_b16 v[52:53], v9 offset:8192
    ds_read_b64_tr_b16 v[54:55], v9 offset:10240
    ds_read_b128 v[56:59], v13 offset:0
    ds_read_b128 v[60:63], v13 offset:4096
    s_waitcnt lgkmcnt(10)
    v_mfma_f32_32x32x16_bf16 v[64:79], v[32:35], v[40:43], v[64:79]
    ds_read_b128 v[208:211], v29 offset:256
    v_mfma_f32_32x32x16_bf16 v[80:95], v[32:35], v[44:47], v[80:95]
    ds_read_b128 v[212:215], v29 offset:2304
    v_mfma_f32_32x32x16_bf16 v[96:111], v[36:39], v[40:43], v[96:111]
    ds_read_b128 v[216:219], v29 offset:4352
    v_mfma_f32_32x32x16_bf16 v[112:127], v[36:39], v[44:47], v[112:127]
    ds_read_b128 v[220:223], v29 offset:6400
    ds_read_b64_tr_b16 v[32:33], v8 offset:16384
    ds_read_b64_tr_b16 v[34:35], v8 offset:18432
    ds_read_b64_tr_b16 v[36:37], v9 offset:16384
    ds_read_b64_tr_b16 v[38:39], v9 offset:18432
    ds_read_b128 v[40:43], v14 offset:0
    ds_read_b128 v[44:47], v14 offset:4096
    s_waitcnt lgkmcnt(10)
    v_mfma_f32_32x32x16_bf16 v[64:79], v[48:51], v[56:59], v[64:79]
    ds_read_b128 v[224:227], v30 offset:256
    v_mfma_f32_32x32x16_bf16 v[80:95], v[48:51], v[60:63], v[80:95]
    ds_read_b128 v[228:231], v30 offset:2304
    v_mfma_f32_32x32x16_bf16 v[96:111], v[52:55], v[56:59], v[96:111]
    ds_read_b128 v[232:235], v30 offset:4352
    v_mfma_f32_32x32x16_bf16 v[112:127], v[52:55], v[60:63], v[112:127]
    ds_read_b128 v[236:239], v30 offset:6400
    ds_read_b64_tr_b16 v[48:49], v8 offset:24576
    ds_read_b64_tr_b16 v[50:51], v8 offset:26624
    ds_read_b64_tr_b16 v[52:53], v9 offset:24576
    ds_read_b64_tr_b16 v[54:55], v9 offset:26624
    ds_read_b128 v[56:59], v15 offset:0
    ds_read_b128 v[60:63], v15 offset:4096
    v_add_u32 v8, 40960, v8
    v_add_u32 v9, 40960, v9
    v_add_u32 v12, 40960, v12
    v_add_u32 v13, 40960, v13
    v_add_u32 v14, 40960, v14
    v_add_u32 v15, 40960, v15
    s_waitcnt lgkmcnt(10)
    v_mfma_f32_32x32x16_bf16 v[64:79], v[32:35], v[40:43], v[64:79]
    ds_read_b128 v[240:243], v31 offset:256
    v_mfma_f32_32x32x16_bf16 v[80:95], v[32:35], v[44:47], v[80:95]
    ds_read_b128 v[244:247], v31 offset:2304
    v_mfma_f32_32x32x16_bf16 v[96:111], v[36:39], v[40:43], v[96:111]
    ds_read_b128 v[248:251], v31 offset:4352
    v_mfma_f32_32x32x16_bf16 v[112:127], v[36:39], v[44:47], v[112:127]
    ds_read_b128 v[252:255], v31 offset:6400
    s_waitcnt lgkmcnt(4)
    s_waitcnt lgkmcnt(0)
    s_barrier
    ds_read_b64_tr_b16 v[32:33], v8 offset:0
    ds_read_b64_tr_b16 v[34:35], v8 offset:2048
    ds_read_b64_tr_b16 v[36:37], v9 offset:0
    ds_read_b64_tr_b16 v[38:39], v9 offset:2048
    ds_read_b128 v[40:43], v12 offset:0
    ds_read_b128 v[44:47], v12 offset:4096
    v_mfma_f32_32x32x16_bf16 v[64:79], v[48:51], v[56:59], v[64:79]
    v_mfma_f32_32x32x16_bf16 v[80:95], v[48:51], v[60:63], v[80:95]
    v_mfma_f32_32x32x16_bf16 v[96:111], v[52:55], v[56:59], v[96:111]
    v_mfma_f32_32x32x16_bf16 v[112:127], v[52:55], v[60:63], v[112:127]
    ds_read_b64_tr_b16 v[48:49], v8 offset:8192
    ds_read_b64_tr_b16 v[50:51], v8 offset:10240
    ds_read_b64_tr_b16 v[52:53], v9 offset:8192
    ds_read_b64_tr_b16 v[54:55], v9 offset:10240
    ds_read_b128 v[56:59], v13 offset:0
    ds_read_b128 v[60:63], v13 offset:4096
    s_waitcnt lgkmcnt(6)
    v_mfma_f32_32x32x16_bf16 v[64:79], v[32:35], v[40:43], v[64:79]
    v_mfma_f32_32x32x16_bf16 v[80:95], v[32:35], v[44:47], v[80:95]
    v_mfma_f32_32x32x16_bf16 v[96:111], v[36:39], v[40:43], v[96:111]
    v_mfma_f32_32x32x16_bf16 v[112:127], v[36:39], v[44:47], v[112:127]
    ds_read_b64_tr_b16 v[32:33], v8 offset:16384
    ds_read_b64_tr_b16 v[34:35], v8 offset:18432
    ds_read_b64_tr_b16 v[36:37], v9 offset:16384
    ds_read_b64_tr_b16 v[38:39], v9 offset:18432
    ds_read_b128 v[40:43], v14 offset:0
    ds_read_b128 v[44:47], v14 offset:4096
    s_waitcnt lgkmcnt(6)
    v_mfma_f32_32x32x16_bf16 v[64:79], v[48:51], v[56:59], v[64:79]
    v_mfma_f32_32x32x16_bf16 v[80:95], v[48:51], v[60:63], v[80:95]
    v_mfma_f32_32x32x16_bf16 v[96:111], v[52:55], v[56:59], v[96:111]
    v_mfma_f32_32x32x16_bf16 v[112:127], v[52:55], v[60:63], v[112:127]
    ds_read_b64_tr_b16 v[48:49], v8 offset:24576
    ds_read_b64_tr_b16 v[50:51], v8 offset:26624
    ds_read_b64_tr_b16 v[52:53], v9 offset:24576
    ds_read_b64_tr_b16 v[54:55], v9 offset:26624
    ds_read_b128 v[56:59], v15 offset:0
    ds_read_b128 v[60:63], v15 offset:4096
    s_waitcnt lgkmcnt(6)
    v_mfma_f32_32x32x16_bf16 v[64:79], v[32:35], v[40:43], v[64:79]
    v_mfma_f32_32x32x16_bf16 v[80:95], v[32:35], v[44:47], v[80:95]
    v_mfma_f32_32x32x16_bf16 v[96:111], v[36:39], v[40:43], v[96:111]
    v_mfma_f32_32x32x16_bf16 v[112:127], v[36:39], v[44:47], v[112:127]
    s_waitcnt lgkmcnt(0)
    v_mfma_f32_32x32x16_bf16 v[64:79], v[48:51], v[56:59], v[64:79]
    v_mfma_f32_32x32x16_bf16 v[80:95], v[48:51], v[60:63], v[80:95]
    v_mfma_f32_32x32x16_bf16 v[96:111], v[52:55], v[56:59], v[96:111]
    v_mfma_f32_32x32x16_bf16 v[112:127], v[52:55], v[60:63], v[112:127]
    v_mov_b32 v2, s21
    v_mov_b32 v1, 118784
    ds_write_b32 v1, v2
    s_nop 5
    v_cvt_pk_bf16_f32 v32, v64, v65
    v_cvt_pk_bf16_f32 v33, v66, v67
    v_cvt_pk_bf16_f32 v34, v68, v69
    v_cvt_pk_bf16_f32 v35, v70, v71
    ds_write_b128 v20, v[32:35] offset:0
    v_cvt_pk_bf16_f32 v36, v72, v73
    v_cvt_pk_bf16_f32 v37, v74, v75
    v_cvt_pk_bf16_f32 v38, v76, v77
    v_cvt_pk_bf16_f32 v39, v78, v79
    v_xor_b32 v2, 16, v20
    ds_write_b128 v2, v[36:39] offset:0
    v_cvt_pk_bf16_f32 v40, v80, v81
    v_cvt_pk_bf16_f32 v41, v82, v83
    v_cvt_pk_bf16_f32 v42, v84, v85
    v_cvt_pk_bf16_f32 v43, v86, v87
    ds_write_b128 v20, v[40:43] offset:16384
    v_cvt_pk_bf16_f32 v44, v88, v89
    v_cvt_pk_bf16_f32 v45, v90, v91
    v_cvt_pk_bf16_f32 v46, v92, v93
    v_cvt_pk_bf16_f32 v47, v94, v95
    v_xor_b32 v2, 16, v20
    ds_write_b128 v2, v[44:47] offset:16384
    v_cvt_pk_bf16_f32 v48, v96, v97
    v_cvt_pk_bf16_f32 v49, v98, v99
    v_cvt_pk_bf16_f32 v50, v100, v101
    v_cvt_pk_bf16_f32 v51, v102, v103
    v_xor_b32 v1, 64, v20
    ds_write_b128 v1, v[48:51] offset:0
    v_cvt_pk_bf16_f32 v52, v104, v105
    v_cvt_pk_bf16_f32 v53, v106, v107
    v_cvt_pk_bf16_f32 v54, v108, v109
    v_cvt_pk_bf16_f32 v55, v110, v111
    v_xor_b32 v2, 80, v20
    ds_write_b128 v2, v[52:55] offset:0
    v_cvt_pk_bf16_f32 v56, v112, v113
    v_cvt_pk_bf16_f32 v57, v114, v115
    v_cvt_pk_bf16_f32 v58, v116, v117
    v_cvt_pk_bf16_f32 v59, v118, v119
    v_xor_b32 v1, 64, v20
    ds_write_b128 v1, v[56:59] offset:16384
    v_cvt_pk_bf16_f32 v60, v120, v121
    v_cvt_pk_bf16_f32 v61, v122, v123
    v_cvt_pk_bf16_f32 v62, v124, v125
    v_cvt_pk_bf16_f32 v63, v126, v127
    v_xor_b32 v2, 80, v20
    ds_write_b128 v2, v[60:63] offset:16384
    s_waitcnt lgkmcnt(0)
    s_barrier
    ds_read_b128 v[64:67], v24 offset:0
    ds_read_b128 v[68:71], v25 offset:0
    ds_read_b128 v[72:75], v26 offset:0
    ds_read_b128 v[76:79], v27 offset:0
    ds_read_b128 v[80:83], v24 offset:256
    ds_read_b128 v[84:87], v25 offset:256
    ds_read_b128 v[88:91], v26 offset:256
    ds_read_b128 v[92:95], v27 offset:256
    s_waitcnt lgkmcnt(7)
    v_mfma_f32_16x16x32_bf16 v[96:99], v[128:131], v[64:67], 0
    v_mfma_f32_16x16x32_bf16 v[100:103], v[132:135], v[64:67], 0
    v_mfma_f32_16x16x32_bf16 v[104:107], v[136:139], v[64:67], 0
    v_mfma_f32_16x16x32_bf16 v[108:111], v[140:143], v[64:67], 0
    s_waitcnt lgkmcnt(6)
    v_mfma_f32_16x16x32_bf16 v[96:99], v[144:147], v[68:71], v[96:99]
    v_mfma_f32_16x16x32_bf16 v[100:103], v[148:151], v[68:71], v[100:103]
    v_mfma_f32_16x16x32_bf16 v[104:107], v[152:155], v[68:71], v[104:107]
    v_mfma_f32_16x16x32_bf16 v[108:111], v[156:159], v[68:71], v[108:111]
    s_waitcnt lgkmcnt(5)
    v_mfma_f32_16x16x32_bf16 v[96:99], v[160:163], v[72:75], v[96:99]
    v_mfma_f32_16x16x32_bf16 v[100:103], v[164:167], v[72:75], v[100:103]
    v_mfma_f32_16x16x32_bf16 v[104:107], v[168:171], v[72:75], v[104:107]
    v_mfma_f32_16x16x32_bf16 v[108:111], v[172:175], v[72:75], v[108:111]
    s_waitcnt lgkmcnt(4)
    v_mfma_f32_16x16x32_bf16 v[96:99], v[176:179], v[76:79], v[96:99]
    v_mfma_f32_16x16x32_bf16 v[100:103], v[180:183], v[76:79], v[100:103]
    v_mfma_f32_16x16x32_bf16 v[104:107], v[184:187], v[76:79], v[104:107]
    v_mfma_f32_16x16x32_bf16 v[108:111], v[188:191], v[76:79], v[108:111]
    s_waitcnt lgkmcnt(3)
    v_mfma_f32_16x16x32_bf16 v[96:99], v[192:195], v[80:83], v[96:99]
    v_mfma_f32_16x16x32_bf16 v[100:103], v[196:199], v[80:83], v[100:103]
    v_mfma_f32_16x16x32_bf16 v[104:107], v[200:203], v[80:83], v[104:107]
    v_mfma_f32_16x16x32_bf16 v[108:111], v[204:207], v[80:83], v[108:111]
    s_waitcnt lgkmcnt(2)
    v_mfma_f32_16x16x32_bf16 v[96:99], v[208:211], v[84:87], v[96:99]
    v_mfma_f32_16x16x32_bf16 v[100:103], v[212:215], v[84:87], v[100:103]
    v_mfma_f32_16x16x32_bf16 v[104:107], v[216:219], v[84:87], v[104:107]
    v_mfma_f32_16x16x32_bf16 v[108:111], v[220:223], v[84:87], v[108:111]
    s_waitcnt lgkmcnt(1)
    v_mfma_f32_16x16x32_bf16 v[96:99], v[224:227], v[88:91], v[96:99]
    v_mfma_f32_16x16x32_bf16 v[100:103], v[228:231], v[88:91], v[100:103]
    v_mfma_f32_16x16x32_bf16 v[104:107], v[232:235], v[88:91], v[104:107]
    v_mfma_f32_16x16x32_bf16 v[108:111], v[236:239], v[88:91], v[108:111]
    s_waitcnt lgkmcnt(0)
    v_mfma_f32_16x16x32_bf16 v[96:99], v[240:243], v[92:95], v[96:99]
    v_mfma_f32_16x16x32_bf16 v[100:103], v[244:247], v[92:95], v[100:103]
    v_mfma_f32_16x16x32_bf16 v[104:107], v[248:251], v[92:95], v[104:107]
    v_mfma_f32_16x16x32_bf16 v[108:111], v[252:255], v[92:95], v[108:111]
    s_nop 4
    v_cvt_pk_bf16_f32 v64, v96, v97
    v_cvt_pk_bf16_f32 v65, v98, v99
    v_cvt_pk_bf16_f32 v66, v100, v101
    v_cvt_pk_bf16_f32 v67, v102, v103
    v_cvt_pk_bf16_f32 v68, v104, v105
    v_cvt_pk_bf16_f32 v69, v106, v107
    v_cvt_pk_bf16_f32 v70, v108, v109
    v_cvt_pk_bf16_f32 v71, v110, v111
    v_lshlrev_b32 v96, 16, v64
    v_and_b32 v97, 0xffff0000, v64
    v_lshlrev_b32 v98, 16, v65
    v_and_b32 v99, 0xffff0000, v65
    v_lshlrev_b32 v100, 16, v66
    v_and_b32 v101, 0xffff0000, v66
    v_lshlrev_b32 v102, 16, v67
    v_and_b32 v103, 0xffff0000, v67
    v_lshlrev_b32 v104, 16, v68
    v_and_b32 v105, 0xffff0000, v68
    v_lshlrev_b32 v106, 16, v69
    v_and_b32 v107, 0xffff0000, v69
    v_lshlrev_b32 v108, 16, v70
    v_and_b32 v109, 0xffff0000, v70
    v_lshlrev_b32 v110, 16, v71
    v_and_b32 v111, 0xffff0000, v71
    v_max3_f32 v72, v96, v97, v98
    v_max3_f32 v72, v72, v99, v100
    v_max3_f32 v72, v72, v101, v102
    v_max3_f32 v72, v72, v103, v104
    v_max3_f32 v72, v72, v105, v106
    v_max3_f32 v72, v72, v107, v108
    v_max3_f32 v72, v72, v109, v110
    v_max_f32 v72, v72, v111
    v_mov_b32 v73, v72
    s_nop 1
    v_permlane16_swap_b32 v72, v73
    v_max_f32 v72, v72, v73
    v_mov_b32 v73, v72
    s_nop 1
    v_permlane32_swap_b32 v72, v73
    v_max_f32 v72, v72, v73
    v_mul_f32 v72, s20, v72
    v_fma_f32 v96, v96, s20, -v72
    v_fma_f32 v97, v97, s20, -v72
    v_fma_f32 v98, v98, s20, -v72
    v_fma_f32 v99, v99, s20, -v72
    v_fma_f32 v100, v100, s20, -v72
    v_fma_f32 v101, v101, s20, -v72
    v_fma_f32 v102, v102, s20, -v72
    v_fma_f32 v103, v103, s20, -v72
    v_fma_f32 v104, v104, s20, -v72
    v_fma_f32 v105, v105, s20, -v72
    v_fma_f32 v106, v106, s20, -v72
    v_fma_f32 v107, v107, s20, -v72
    v_fma_f32 v108, v108, s20, -v72
    v_fma_f32 v109, v109, s20, -v72
    v_fma_f32 v110, v110, s20, -v72
    v_fma_f32 v111, v111, s20, -v72
    v_exp_f32 v96, v96
    v_exp_f32 v97, v97
    v_exp_f32 v98, v98
    v_exp_f32 v99, v99
    v_exp_f32 v100, v100
    v_exp_f32 v101, v101
    v_exp_f32 v102, v102
    v_exp_f32 v103, v103
    v_exp_f32 v104, v104
    v_exp_f32 v105, v105
    v_exp_f32 v106, v106
    v_exp_f32 v107, v107
    v_exp_f32 v108, v108
    v_exp_f32 v109, v109
    v_exp_f32 v110, v110
    v_exp_f32 v111, v111
    v_add_f32 v74, v96, v97
    v_add_f32 v75, v98, v99
    v_add_f32 v76, v100, v101
    v_add_f32 v77, v102, v103
    v_add_f32 v78, v104, v105
    v_add_f32 v79, v106, v107
    v_add_f32 v80, v108, v109
    v_add_f32 v81, v110, v111
    v_add_f32 v74, v74, v78
    v_add_f32 v75, v75, v79
    v_add_f32 v76, v76, v80
    v_add_f32 v77, v77, v81
    v_add_f32 v74, v74, v75
    v_add_f32 v76, v76, v77
    v_add_f32 v74, v74, v76
    v_mov_b32 v73, v74
    s_nop 1
    v_permlane16_swap_b32 v74, v73
    v_add_f32 v74, v74, v73
    v_mov_b32 v73, v74
    s_nop 1
    v_permlane32_swap_b32 v74, v73
    v_add_f32 v74, v74, v73
    v_rcp_f32 v74, v74
    s_nop 0
    v_mul_f32 v96, v96, v74
    v_mul_f32 v97, v97, v74
    v_mul_f32 v98, v98, v74
    v_mul_f32 v99, v99, v74
    v_mul_f32 v100, v100, v74
    v_mul_f32 v101, v101, v74
    v_mul_f32 v102, v102, v74
    v_mul_f32 v103, v103, v74
    v_mul_f32 v104, v104, v74
    v_mul_f32 v105, v105, v74
    v_mul_f32 v106, v106, v74
    v_mul_f32 v107, v107, v74
    v_mul_f32 v108, v108, v74
    v_mul_f32 v109, v109, v74
    v_mul_f32 v110, v110, v74
    v_mul_f32 v111, v111, v74
    v_cvt_pk_bf16_f32 v64, v96, v97
    v_cvt_pk_bf16_f32 v65, v98, v99
    v_cvt_pk_bf16_f32 v66, v100, v101
    v_cvt_pk_bf16_f32 v67, v102, v103
    v_cvt_pk_bf16_f32 v68, v104, v105
    v_cvt_pk_bf16_f32 v69, v106, v107
    v_cvt_pk_bf16_f32 v70, v108, v109
    v_cvt_pk_bf16_f32 v71, v110, v111
    v_lshrrev_b32 v82, 1, v22
    v_lshlrev_b32 v82, 11, v82
    v_and_b32 v83, 1, v22
    v_lshlrev_b32 v83, 9, v83
    v_add_u32 v82, v82, v83
    v_lshlrev_b32 v83, 4, v21
    v_add_u32 v82, v82, v83
    s_lshl_b32 s22, s71, 13
    s_lshr_b32 s74, s68, 1
    s_lshl_b32 s74, s74, 12
    s_add_u32 s22, s22, s74
    s_and_b32 s74, s68, 1
    s_lshl_b32 s74, s74, 8
    s_add_u32 s22, s22, s74
    buffer_store_dwordx4 v[64:67], v82, s[52:55], s22 offen offset:0 sc1
    buffer_store_dwordx4 v[68:71], v82, s[52:55], s22 offen offset:1024 sc1
    s_lshl_b32 s26, s71, 5
    s_lshl_b32 s74, s68, 2
    s_add_u32 s26, s26, s74
    s_add_u32 s26, s26, 2097152
    v_mov_b32 v84, 0x40000000
    v_cmp_eq_u32 vcc, 0, v0
    v_mov_b32 v86, s21
    s_nop 0
    v_cndmask_b32 v85, v84, 0, vcc
    s_barrier
    ds_read_b64_tr_b16 v[40:41], v10 offset:0
    ds_read_b64_tr_b16 v[42:43], v10 offset:1024
    ds_read_b64_tr_b16 v[44:45], v10 offset:16384
    ds_read_b64_tr_b16 v[46:47], v10 offset:17408
    ds_read_b128 v[32:35], v16 offset:0
    ds_read_b128 v[36:39], v16 offset:4096
    ds_read_b64_tr_b16 v[56:57], v10 offset:4096
    ds_read_b64_tr_b16 v[58:59], v10 offset:5120
    ds_read_b64_tr_b16 v[60:61], v10 offset:20480
    ds_read_b64_tr_b16 v[62:63], v10 offset:21504
    ds_read_b128 v[48:51], v17 offset:0
    ds_read_b128 v[52:55], v17 offset:4096
    s_waitcnt lgkmcnt(6)
    v_mfma_f32_32x32x16_bf16 v[128:143], v[32:35], v[40:43], 0
    v_mfma_f32_32x32x16_bf16 v[144:159], v[36:39], v[40:43], 0
    v_mfma_f32_32x32x16_bf16 v[160:175], v[32:35], v[44:47], 0
    v_mfma_f32_32x32x16_bf16 v[176:191], v[36:39], v[44:47], 0
    ds_read_b64_tr_b16 v[40:41], v10 offset:8192
    ds_read_b64_tr_b16 v[42:43], v10 offset:9216
    ds_read_b64_tr_b16 v[44:45], v10 offset:24576
    ds_read_b64_tr_b16 v[46:47], v10 offset:25600
    ds_read_b128 v[32:35], v18 offset:0
    ds_read_b128 v[36:39], v18 offset:4096
    s_waitcnt lgkmcnt(6)
    v_mfma_f32_32x32x16_bf16 v[128:143], v[48:51], v[56:59], v[128:143]
    v_mfma_f32_32x32x16_bf16 v[144:159], v[52:55], v[56:59], v[144:159]
    v_mfma_f32_32x32x16_bf16 v[160:175], v[48:51], v[60:63], v[160:175]
    v_mfma_f32_32x32x16_bf16 v[176:191], v[52:55], v[60:63], v[176:191]
    ds_read_b64_tr_b16 v[56:57], v10 offset:12288
    ds_read_b64_tr_b16 v[58:59], v10 offset:13312
    ds_read_b64_tr_b16 v[60:61], v10 offset:28672
    ds_read_b64_tr_b16 v[62:63], v10 offset:29696
    ds_read_b128 v[48:51], v19 offset:0
    ds_read_b128 v[52:55], v19 offset:4096
    v_subrev_u32 v10, 40960, v10
    v_subrev_u32 v16, 40960, v16
    v_subrev_u32 v17, 40960, v17
    v_subrev_u32 v18, 40960, v18
    v_subrev_u32 v19, 40960, v19
    s_waitcnt lgkmcnt(6)
    v_mfma_f32_32x32x16_bf16 v[128:143], v[32:35], v[40:43], v[128:143]
    v_mfma_f32_32x32x16_bf16 v[144:159], v[36:39], v[40:43], v[144:159]
    v_mfma_f32_32x32x16_bf16 v[160:175], v[32:35], v[44:47], v[160:175]
    v_mfma_f32_32x32x16_bf16 v[176:191], v[36:39], v[44:47], v[176:191]
    s_waitcnt lgkmcnt(0)
    s_waitcnt vmcnt(0)
    buffer_store_dword v86, v85, s[52:55], s26 offen sc1
    s_barrier
    ds_read_b64_tr_b16 v[40:41], v10 offset:0
    ds_read_b64_tr_b16 v[42:43], v10 offset:1024
    ds_read_b64_tr_b16 v[44:45], v10 offset:16384
    ds_read_b64_tr_b16 v[46:47], v10 offset:17408
    ds_read_b128 v[32:35], v16 offset:0
    ds_read_b128 v[36:39], v16 offset:4096
    v_mfma_f32_32x32x16_bf16 v[128:143], v[48:51], v[56:59], v[128:143]
    v_mfma_f32_32x32x16_bf16 v[144:159], v[52:55], v[56:59], v[144:159]
    v_mfma_f32_32x32x16_bf16 v[160:175], v[48:51], v[60:63], v[160:175]
    v_mfma_f32_32x32x16_bf16 v[176:191], v[52:55], v[60:63], v[176:191]
    ds_read_b64_tr_b16 v[56:57], v10 offset:4096
    ds_read_b64_tr_b16 v[58:59], v10 offset:5120
    ds_read_b64_tr_b16 v[60:61], v10 offset:20480
    ds_read_b64_tr_b16 v[62:63], v10 offset:21504
    ds_read_b128 v[48:51], v17 offset:0
    ds_read_b128 v[52:55], v17 offset:4096
    s_waitcnt lgkmcnt(6)
    v_mfma_f32_32x32x16_bf16 v[128:143], v[32:35], v[40:43], v[128:143]
    v_mfma_f32_32x32x16_bf16 v[144:159], v[36:39], v[40:43], v[144:159]
    v_mfma_f32_32x32x16_bf16 v[160:175], v[32:35], v[44:47], v[160:175]
    v_mfma_f32_32x32x16_bf16 v[176:191], v[36:39], v[44:47], v[176:191]
    ds_read_b64_tr_b16 v[40:41], v10 offset:8192
    ds_read_b64_tr_b16 v[42:43], v10 offset:9216
    ds_read_b64_tr_b16 v[44:45], v10 offset:24576
    ds_read_b64_tr_b16 v[46:47], v10 offset:25600
    ds_read_b128 v[32:35], v18 offset:0
    ds_read_b128 v[36:39], v18 offset:4096
    s_waitcnt lgkmcnt(6)
    v_mfma_f32_32x32x16_bf16 v[128:143], v[48:51], v[56:59], v[128:143]
    v_mfma_f32_32x32x16_bf16 v[144:159], v[52:55], v[56:59], v[144:159]
    v_mfma_f32_32x32x16_bf16 v[160:175], v[48:51], v[60:63], v[160:175]
    v_mfma_f32_32x32x16_bf16 v[176:191], v[52:55], v[60:63], v[176:191]
    ds_read_b64_tr_b16 v[56:57], v10 offset:12288
    ds_read_b64_tr_b16 v[58:59], v10 offset:13312
    ds_read_b64_tr_b16 v[60:61], v10 offset:28672
    ds_read_b64_tr_b16 v[62:63], v10 offset:29696
    ds_read_b128 v[48:51], v19 offset:0
    ds_read_b128 v[52:55], v19 offset:4096
    v_add_u32 v10, 122880, v10
    v_add_u32 v16, 122880, v16
    v_add_u32 v17, 122880, v17
    v_add_u32 v18, 122880, v18
    v_add_u32 v19, 122880, v19
    s_waitcnt lgkmcnt(6)
    v_mfma_f32_32x32x16_bf16 v[128:143], v[32:35], v[40:43], v[128:143]
    v_mfma_f32_32x32x16_bf16 v[144:159], v[36:39], v[40:43], v[144:159]
    v_mfma_f32_32x32x16_bf16 v[160:175], v[32:35], v[44:47], v[160:175]
    v_mfma_f32_32x32x16_bf16 v[176:191], v[36:39], v[44:47], v[176:191]
    s_waitcnt lgkmcnt(0)
    s_barrier
    ds_read_b64_tr_b16 v[40:41], v10 offset:0
    ds_read_b64_tr_b16 v[42:43], v10 offset:1024
    ds_read_b64_tr_b16 v[44:45], v10 offset:16384
    ds_read_b64_tr_b16 v[46:47], v10 offset:17408
    ds_read_b128 v[32:35], v16 offset:0
    ds_read_b128 v[36:39], v16 offset:4096
    v_mfma_f32_32x32x16_bf16 v[128:143], v[48:51], v[56:59], v[128:143]
    v_mfma_f32_32x32x16_bf16 v[144:159], v[52:55], v[56:59], v[144:159]
    v_mfma_f32_32x32x16_bf16 v[160:175], v[48:51], v[60:63], v[160:175]
    v_mfma_f32_32x32x16_bf16 v[176:191], v[52:55], v[60:63], v[176:191]
    ds_read_b64_tr_b16 v[56:57], v10 offset:4096
    ds_read_b64_tr_b16 v[58:59], v10 offset:5120
    ds_read_b64_tr_b16 v[60:61], v10 offset:20480
    ds_read_b64_tr_b16 v[62:63], v10 offset:21504
    ds_read_b128 v[48:51], v17 offset:0
    ds_read_b128 v[52:55], v17 offset:4096
    s_waitcnt lgkmcnt(6)
    v_mfma_f32_32x32x16_bf16 v[128:143], v[32:35], v[40:43], v[128:143]
    v_mfma_f32_32x32x16_bf16 v[144:159], v[36:39], v[40:43], v[144:159]
    v_mfma_f32_32x32x16_bf16 v[160:175], v[32:35], v[44:47], v[160:175]
    v_mfma_f32_32x32x16_bf16 v[176:191], v[36:39], v[44:47], v[176:191]
    ds_read_b64_tr_b16 v[40:41], v10 offset:8192
    ds_read_b64_tr_b16 v[42:43], v10 offset:9216
    ds_read_b64_tr_b16 v[44:45], v10 offset:24576
    ds_read_b64_tr_b16 v[46:47], v10 offset:25600
    ds_read_b128 v[32:35], v18 offset:0
    ds_read_b128 v[36:39], v18 offset:4096
    s_waitcnt lgkmcnt(6)
    v_mfma_f32_32x32x16_bf16 v[128:143], v[48:51], v[56:59], v[128:143]
    v_mfma_f32_32x32x16_bf16 v[144:159], v[52:55], v[56:59], v[144:159]
    v_mfma_f32_32x32x16_bf16 v[160:175], v[48:51], v[60:63], v[160:175]
    v_mfma_f32_32x32x16_bf16 v[176:191], v[52:55], v[60:63], v[176:191]
    ds_read_b64_tr_b16 v[56:57], v10 offset:12288
    ds_read_b64_tr_b16 v[58:59], v10 offset:13312
    ds_read_b64_tr_b16 v[60:61], v10 offset:28672
    ds_read_b64_tr_b16 v[62:63], v10 offset:29696
    ds_read_b128 v[48:51], v19 offset:0
    ds_read_b128 v[52:55], v19 offset:4096
    v_subrev_u32 v10, 40960, v10
    v_subrev_u32 v16, 40960, v16
    v_subrev_u32 v17, 40960, v17
    v_subrev_u32 v18, 40960, v18
    v_subrev_u32 v19, 40960, v19
    s_waitcnt lgkmcnt(6)
    v_mfma_f32_32x32x16_bf16 v[128:143], v[32:35], v[40:43], v[128:143]
    v_mfma_f32_32x32x16_bf16 v[144:159], v[36:39], v[40:43], v[144:159]
    v_mfma_f32_32x32x16_bf16 v[160:175], v[32:35], v[44:47], v[160:175]
    v_mfma_f32_32x32x16_bf16 v[176:191], v[36:39], v[44:47], v[176:191]
    s_waitcnt lgkmcnt(0)
    s_barrier
    ds_read_b64_tr_b16 v[40:41], v10 offset:0
    ds_read_b64_tr_b16 v[42:43], v10 offset:1024
    ds_read_b64_tr_b16 v[44:45], v10 offset:16384
    ds_read_b64_tr_b16 v[46:47], v10 offset:17408
    ds_read_b128 v[32:35], v16 offset:0
    ds_read_b128 v[36:39], v16 offset:4096
    v_mfma_f32_32x32x16_bf16 v[128:143], v[48:51], v[56:59], v[128:143]
    v_mfma_f32_32x32x16_bf16 v[144:159], v[52:55], v[56:59], v[144:159]
    v_mfma_f32_32x32x16_bf16 v[160:175], v[48:51], v[60:63], v[160:175]
    v_mfma_f32_32x32x16_bf16 v[176:191], v[52:55], v[60:63], v[176:191]
    ds_read_b64_tr_b16 v[56:57], v10 offset:4096
    ds_read_b64_tr_b16 v[58:59], v10 offset:5120
    ds_read_b64_tr_b16 v[60:61], v10 offset:20480
    ds_read_b64_tr_b16 v[62:63], v10 offset:21504
    ds_read_b128 v[48:51], v17 offset:0
    ds_read_b128 v[52:55], v17 offset:4096
    s_waitcnt lgkmcnt(6)
    v_mfma_f32_32x32x16_bf16 v[128:143], v[32:35], v[40:43], v[128:143]
    v_mfma_f32_32x32x16_bf16 v[144:159], v[36:39], v[40:43], v[144:159]
    v_mfma_f32_32x32x16_bf16 v[160:175], v[32:35], v[44:47], v[160:175]
    v_mfma_f32_32x32x16_bf16 v[176:191], v[36:39], v[44:47], v[176:191]
    ds_read_b64_tr_b16 v[40:41], v10 offset:8192
    ds_read_b64_tr_b16 v[42:43], v10 offset:9216
    ds_read_b64_tr_b16 v[44:45], v10 offset:24576
    ds_read_b64_tr_b16 v[46:47], v10 offset:25600
    ds_read_b128 v[32:35], v18 offset:0
    ds_read_b128 v[36:39], v18 offset:4096
    s_waitcnt lgkmcnt(6)
    v_mfma_f32_32x32x16_bf16 v[128:143], v[48:51], v[56:59], v[128:143]
    v_mfma_f32_32x32x16_bf16 v[144:159], v[52:55], v[56:59], v[144:159]
    v_mfma_f32_32x32x16_bf16 v[160:175], v[48:51], v[60:63], v[160:175]
    v_mfma_f32_32x32x16_bf16 v[176:191], v[52:55], v[60:63], v[176:191]
    ds_read_b64_tr_b16 v[56:57], v10 offset:12288
    ds_read_b64_tr_b16 v[58:59], v10 offset:13312
    ds_read_b64_tr_b16 v[60:61], v10 offset:28672
    ds_read_b64_tr_b16 v[62:63], v10 offset:29696
    ds_read_b128 v[48:51], v19 offset:0
    ds_read_b128 v[52:55], v19 offset:4096
    v_subrev_u32 v10, 40960, v10
    v_subrev_u32 v16, 40960, v16
    v_subrev_u32 v17, 40960, v17
    v_subrev_u32 v18, 40960, v18
    v_subrev_u32 v19, 40960, v19
    s_waitcnt lgkmcnt(6)
    v_mfma_f32_32x32x16_bf16 v[128:143], v[32:35], v[40:43], v[128:143]
    v_mfma_f32_32x32x16_bf16 v[144:159], v[36:39], v[40:43], v[144:159]
    v_mfma_f32_32x32x16_bf16 v[160:175], v[32:35], v[44:47], v[160:175]
    v_mfma_f32_32x32x16_bf16 v[176:191], v[36:39], v[44:47], v[176:191]
    s_waitcnt lgkmcnt(0)
    s_barrier
    ds_read_b64_tr_b16 v[40:41], v10 offset:0
    ds_read_b64_tr_b16 v[42:43], v10 offset:1024
    ds_read_b64_tr_b16 v[44:45], v10 offset:16384
    ds_read_b64_tr_b16 v[46:47], v10 offset:17408
    ds_read_b128 v[32:35], v16 offset:0
    ds_read_b128 v[36:39], v16 offset:4096
    v_mfma_f32_32x32x16_bf16 v[128:143], v[48:51], v[56:59], v[128:143]
    v_mfma_f32_32x32x16_bf16 v[144:159], v[52:55], v[56:59], v[144:159]
    v_mfma_f32_32x32x16_bf16 v[160:175], v[48:51], v[60:63], v[160:175]
    v_mfma_f32_32x32x16_bf16 v[176:191], v[52:55], v[60:63], v[176:191]
    ds_read_b64_tr_b16 v[56:57], v10 offset:4096
    ds_read_b64_tr_b16 v[58:59], v10 offset:5120
    ds_read_b64_tr_b16 v[60:61], v10 offset:20480
    ds_read_b64_tr_b16 v[62:63], v10 offset:21504
    ds_read_b128 v[48:51], v17 offset:0
    ds_read_b128 v[52:55], v17 offset:4096
    s_waitcnt lgkmcnt(6)
    v_mfma_f32_32x32x16_bf16 v[64:79], v[32:35], v[40:43], 0
    v_mfma_f32_32x32x16_bf16 v[80:95], v[36:39], v[40:43], 0
    v_mfma_f32_32x32x16_bf16 v[96:111], v[32:35], v[44:47], 0
    v_mfma_f32_32x32x16_bf16 v[112:127], v[36:39], v[44:47], 0
    ds_read_b64_tr_b16 v[40:41], v10 offset:8192
    ds_read_b64_tr_b16 v[42:43], v10 offset:9216
    ds_read_b64_tr_b16 v[44:45], v10 offset:24576
    ds_read_b64_tr_b16 v[46:47], v10 offset:25600
    ds_read_b128 v[32:35], v18 offset:0
    ds_read_b128 v[36:39], v18 offset:4096
    s_waitcnt lgkmcnt(6)
    v_mfma_f32_32x32x16_bf16 v[64:79], v[48:51], v[56:59], v[64:79]
    v_mfma_f32_32x32x16_bf16 v[80:95], v[52:55], v[56:59], v[80:95]
    v_mfma_f32_32x32x16_bf16 v[96:111], v[48:51], v[60:63], v[96:111]
    v_mfma_f32_32x32x16_bf16 v[112:127], v[52:55], v[60:63], v[112:127]
    ds_read_b64_tr_b16 v[56:57], v10 offset:12288
    ds_read_b64_tr_b16 v[58:59], v10 offset:13312
    ds_read_b64_tr_b16 v[60:61], v10 offset:28672
    ds_read_b64_tr_b16 v[62:63], v10 offset:29696
    ds_read_b128 v[48:51], v19 offset:0
    ds_read_b128 v[52:55], v19 offset:4096
    v_subrev_u32 v10, 40960, v10
    v_subrev_u32 v16, 40960, v16
    v_subrev_u32 v17, 40960, v17
    v_subrev_u32 v18, 40960, v18
    v_subrev_u32 v19, 40960, v19
    s_waitcnt lgkmcnt(6)
    v_mfma_f32_32x32x16_bf16 v[64:79], v[32:35], v[40:43], v[64:79]
    v_mfma_f32_32x32x16_bf16 v[80:95], v[36:39], v[40:43], v[80:95]
    v_mfma_f32_32x32x16_bf16 v[96:111], v[32:35], v[44:47], v[96:111]
    v_mfma_f32_32x32x16_bf16 v[112:127], v[36:39], v[44:47], v[112:127]
    s_waitcnt lgkmcnt(0)
    s_barrier
    ds_read_b64_tr_b16 v[40:41], v10 offset:0
    ds_read_b64_tr_b16 v[42:43], v10 offset:1024
    ds_read_b64_tr_b16 v[44:45], v10 offset:16384
    ds_read_b64_tr_b16 v[46:47], v10 offset:17408
    ds_read_b128 v[32:35], v16 offset:0
    ds_read_b128 v[36:39], v16 offset:4096
    v_mfma_f32_32x32x16_bf16 v[64:79], v[48:51], v[56:59], v[64:79]
    v_cvt_pk_bf16_f32 v192, v128, v129
    v_cvt_pk_bf16_f32 v193, v130, v131
    v_cvt_pk_bf16_f32 v194, v132, v133
    v_cvt_pk_bf16_f32 v195, v134, v135
    v_cvt_pk_bf16_f32 v196, v136, v137
    v_mfma_f32_32x32x16_bf16 v[80:95], v[52:55], v[56:59], v[80:95]
    v_cvt_pk_bf16_f32 v197, v138, v139
    v_cvt_pk_bf16_f32 v198, v140, v141
    v_cvt_pk_bf16_f32 v199, v142, v143
    v_cvt_pk_bf16_f32 v200, v144, v145
    v_cvt_pk_bf16_f32 v201, v146, v147
    v_mfma_f32_32x32x16_bf16 v[96:111], v[48:51], v[60:63], v[96:111]
    v_cvt_pk_bf16_f32 v202, v148, v149
    v_cvt_pk_bf16_f32 v203, v150, v151
    v_cvt_pk_bf16_f32 v204, v152, v153
    v_cvt_pk_bf16_f32 v205, v154, v155
    v_cvt_pk_bf16_f32 v206, v156, v157
    v_mfma_f32_32x32x16_bf16 v[112:127], v[52:55], v[60:63], v[112:127]
    v_cvt_pk_bf16_f32 v207, v158, v159
    v_cvt_pk_bf16_f32 v208, v160, v161
    v_cvt_pk_bf16_f32 v209, v162, v163
    v_cvt_pk_bf16_f32 v210, v164, v165
    v_cvt_pk_bf16_f32 v211, v166, v167
    ds_read_b64_tr_b16 v[56:57], v10 offset:4096
    ds_read_b64_tr_b16 v[58:59], v10 offset:5120
    ds_read_b64_tr_b16 v[60:61], v10 offset:20480
    ds_read_b64_tr_b16 v[62:63], v10 offset:21504
    ds_read_b128 v[48:51], v17 offset:0
    ds_read_b128 v[52:55], v17 offset:4096
    s_waitcnt lgkmcnt(6)
    v_mfma_f32_32x32x16_bf16 v[64:79], v[32:35], v[40:43], v[64:79]
    v_cvt_pk_bf16_f32 v212, v168, v169
    v_cvt_pk_bf16_f32 v213, v170, v171
    v_cvt_pk_bf16_f32 v214, v172, v173
    v_cvt_pk_bf16_f32 v215, v174, v175
    v_cvt_pk_bf16_f32 v216, v176, v177
    v_mfma_f32_32x32x16_bf16 v[80:95], v[36:39], v[40:43], v[80:95]
    v_cvt_pk_bf16_f32 v217, v178, v179
    v_cvt_pk_bf16_f32 v218, v180, v181
    v_cvt_pk_bf16_f32 v219, v182, v183
    v_cvt_pk_bf16_f32 v220, v184, v185
    v_cvt_pk_bf16_f32 v221, v186, v187
    v_mfma_f32_32x32x16_bf16 v[96:111], v[32:35], v[44:47], v[96:111]
    v_cvt_pk_bf16_f32 v222, v188, v189
    v_cvt_pk_bf16_f32 v223, v190, v191
    v_mfma_f32_32x32x16_bf16 v[112:127], v[36:39], v[44:47], v[112:127]
    ds_read_b64_tr_b16 v[40:41], v10 offset:8192
    ds_read_b64_tr_b16 v[42:43], v10 offset:9216
    ds_read_b64_tr_b16 v[44:45], v10 offset:24576
    ds_read_b64_tr_b16 v[46:47], v10 offset:25600
    ds_read_b128 v[32:35], v18 offset:0
    ds_read_b128 v[36:39], v18 offset:4096
    s_waitcnt lgkmcnt(6)
    v_mfma_f32_32x32x16_bf16 v[64:79], v[48:51], v[56:59], v[64:79]
    v_mfma_f32_32x32x16_bf16 v[80:95], v[52:55], v[56:59], v[80:95]
    v_mfma_f32_32x32x16_bf16 v[96:111], v[48:51], v[60:63], v[96:111]
    v_mfma_f32_32x32x16_bf16 v[112:127], v[52:55], v[60:63], v[112:127]
    ds_read_b64_tr_b16 v[56:57], v10 offset:12288
    ds_read_b64_tr_b16 v[58:59], v10 offset:13312
    ds_read_b64_tr_b16 v[60:61], v10 offset:28672
    ds_read_b64_tr_b16 v[62:63], v10 offset:29696
    ds_read_b128 v[48:51], v19 offset:0
    ds_read_b128 v[52:55], v19 offset:4096
    v_add_u32 v10, 122880, v10
    v_add_u32 v16, 122880, v16
    v_add_u32 v17, 122880, v17
    v_add_u32 v18, 122880, v18
    v_add_u32 v19, 122880, v19
    s_waitcnt lgkmcnt(6)
    v_mfma_f32_32x32x16_bf16 v[64:79], v[32:35], v[40:43], v[64:79]
    v_mfma_f32_32x32x16_bf16 v[80:95], v[36:39], v[40:43], v[80:95]
    v_mfma_f32_32x32x16_bf16 v[96:111], v[32:35], v[44:47], v[96:111]
    v_mfma_f32_32x32x16_bf16 v[112:127], v[36:39], v[44:47], v[112:127]
    s_waitcnt lgkmcnt(0)
    s_barrier
    ds_read_b64_tr_b16 v[40:41], v10 offset:0
    ds_read_b64_tr_b16 v[42:43], v10 offset:1024
    ds_read_b64_tr_b16 v[44:45], v10 offset:16384
    ds_read_b64_tr_b16 v[46:47], v10 offset:17408
    ds_read_b128 v[32:35], v16 offset:0
    ds_read_b128 v[36:39], v16 offset:4096
    v_mfma_f32_32x32x16_bf16 v[64:79], v[48:51], v[56:59], v[64:79]
    v_mfma_f32_32x32x16_bf16 v[80:95], v[52:55], v[56:59], v[80:95]
    v_mfma_f32_32x32x16_bf16 v[96:111], v[48:51], v[60:63], v[96:111]
    v_mfma_f32_32x32x16_bf16 v[112:127], v[52:55], v[60:63], v[112:127]
    ds_read_b64_tr_b16 v[56:57], v10 offset:4096
    ds_read_b64_tr_b16 v[58:59], v10 offset:5120
    ds_read_b64_tr_b16 v[60:61], v10 offset:20480
    ds_read_b64_tr_b16 v[62:63], v10 offset:21504
    ds_read_b128 v[48:51], v17 offset:0
    ds_read_b128 v[52:55], v17 offset:4096
    s_waitcnt lgkmcnt(6)
    v_mfma_f32_32x32x16_bf16 v[64:79], v[32:35], v[40:43], v[64:79]
    v_mfma_f32_32x32x16_bf16 v[80:95], v[36:39], v[40:43], v[80:95]
    v_mfma_f32_32x32x16_bf16 v[96:111], v[32:35], v[44:47], v[96:111]
    v_mfma_f32_32x32x16_bf16 v[112:127], v[36:39], v[44:47], v[112:127]
    ds_read_b64_tr_b16 v[40:41], v10 offset:8192
    ds_read_b64_tr_b16 v[42:43], v10 offset:9216
    ds_read_b64_tr_b16 v[44:45], v10 offset:24576
    ds_read_b64_tr_b16 v[46:47], v10 offset:25600
    ds_read_b128 v[32:35], v18 offset:0
    ds_read_b128 v[36:39], v18 offset:4096
    s_waitcnt lgkmcnt(6)
    v_mfma_f32_32x32x16_bf16 v[64:79], v[48:51], v[56:59], v[64:79]
    v_mfma_f32_32x32x16_bf16 v[80:95], v[52:55], v[56:59], v[80:95]
    v_mfma_f32_32x32x16_bf16 v[96:111], v[48:51], v[60:63], v[96:111]
    v_mfma_f32_32x32x16_bf16 v[112:127], v[52:55], v[60:63], v[112:127]
    ds_read_b64_tr_b16 v[56:57], v10 offset:12288
    ds_read_b64_tr_b16 v[58:59], v10 offset:13312
    ds_read_b64_tr_b16 v[60:61], v10 offset:28672
    ds_read_b64_tr_b16 v[62:63], v10 offset:29696
    ds_read_b128 v[48:51], v19 offset:0
    ds_read_b128 v[52:55], v19 offset:4096
    v_subrev_u32 v10, 40960, v10
    v_subrev_u32 v16, 40960, v16
    v_subrev_u32 v17, 40960, v17
    v_subrev_u32 v18, 40960, v18
    v_subrev_u32 v19, 40960, v19
    s_waitcnt lgkmcnt(6)
    v_mfma_f32_32x32x16_bf16 v[64:79], v[32:35], v[40:43], v[64:79]
    v_mfma_f32_32x32x16_bf16 v[80:95], v[36:39], v[40:43], v[80:95]
    v_mfma_f32_32x32x16_bf16 v[96:111], v[32:35], v[44:47], v[96:111]
    v_mfma_f32_32x32x16_bf16 v[112:127], v[36:39], v[44:47], v[112:127]
    s_waitcnt lgkmcnt(0)
    s_barrier
    ds_read_b64_tr_b16 v[40:41], v10 offset:0
    ds_read_b64_tr_b16 v[42:43], v10 offset:1024
    ds_read_b64_tr_b16 v[44:45], v10 offset:16384
    ds_read_b64_tr_b16 v[46:47], v10 offset:17408
    ds_read_b128 v[32:35], v16 offset:0
    ds_read_b128 v[36:39], v16 offset:4096
    v_mfma_f32_32x32x16_bf16 v[64:79], v[48:51], v[56:59], v[64:79]
    v_mfma_f32_32x32x16_bf16 v[80:95], v[52:55], v[56:59], v[80:95]
    v_mfma_f32_32x32x16_bf16 v[96:111], v[48:51], v[60:63], v[96:111]
    v_mfma_f32_32x32x16_bf16 v[112:127], v[52:55], v[60:63], v[112:127]
    ds_read_b64_tr_b16 v[56:57], v10 offset:4096
    ds_read_b64_tr_b16 v[58:59], v10 offset:5120
    ds_read_b64_tr_b16 v[60:61], v10 offset:20480
    ds_read_b64_tr_b16 v[62:63], v10 offset:21504
    ds_read_b128 v[48:51], v17 offset:0
    ds_read_b128 v[52:55], v17 offset:4096
    s_waitcnt lgkmcnt(6)
    v_mfma_f32_32x32x16_bf16 v[64:79], v[32:35], v[40:43], v[64:79]
    v_mfma_f32_32x32x16_bf16 v[80:95], v[36:39], v[40:43], v[80:95]
    v_mfma_f32_32x32x16_bf16 v[96:111], v[32:35], v[44:47], v[96:111]
    v_mfma_f32_32x32x16_bf16 v[112:127], v[36:39], v[44:47], v[112:127]
    ds_read_b64_tr_b16 v[40:41], v10 offset:8192
    ds_read_b64_tr_b16 v[42:43], v10 offset:9216
    ds_read_b64_tr_b16 v[44:45], v10 offset:24576
    ds_read_b64_tr_b16 v[46:47], v10 offset:25600
    ds_read_b128 v[32:35], v18 offset:0
    ds_read_b128 v[36:39], v18 offset:4096
    s_waitcnt lgkmcnt(6)
    v_mfma_f32_32x32x16_bf16 v[64:79], v[48:51], v[56:59], v[64:79]
    v_mfma_f32_32x32x16_bf16 v[80:95], v[52:55], v[56:59], v[80:95]
    v_mfma_f32_32x32x16_bf16 v[96:111], v[48:51], v[60:63], v[96:111]
    v_mfma_f32_32x32x16_bf16 v[112:127], v[52:55], v[60:63], v[112:127]
    ds_read_b64_tr_b16 v[56:57], v10 offset:12288
    ds_read_b64_tr_b16 v[58:59], v10 offset:13312
    ds_read_b64_tr_b16 v[60:61], v10 offset:28672
    ds_read_b64_tr_b16 v[62:63], v10 offset:29696
    ds_read_b128 v[48:51], v19 offset:0
    ds_read_b128 v[52:55], v19 offset:4096
    s_waitcnt lgkmcnt(6)
    v_mfma_f32_32x32x16_bf16 v[64:79], v[32:35], v[40:43], v[64:79]
    v_mfma_f32_32x32x16_bf16 v[80:95], v[36:39], v[40:43], v[80:95]
    v_mfma_f32_32x32x16_bf16 v[96:111], v[32:35], v[44:47], v[96:111]
    v_mfma_f32_32x32x16_bf16 v[112:127], v[36:39], v[44:47], v[112:127]
    s_waitcnt lgkmcnt(0)
    s_lshr_b32 s74, s63, 2
    s_and_b32 s74, s74, 1
    s_lshl_b32 s75, s74, 14
    s_add_u32 s75, s75, 40960
    v_lshlrev_b32 v8, 4, v0
    v_add_u32 v9, s75, v8
    s_xor_b32 s74, s74, 1
    s_lshl_b32 s75, s74, 14
    s_add_u32 s75, s75, 40960
    v_add_u32 v10, s75, v8
    s_lshl_b32 s74, s68, 2
    s_add_u32 s74, s74, s67
    s_add_u32 s74, s74, s70
    s_lshl_b32 s74, s74, 14
    s_lshl_b32 s75, s65, 12
    s_add_u32 s23, s74, s75
    s_add_u32 s23, s23, 2162688
    s_cmp_eq_u32 s68, s65
    s_cselect_b32 s23, 0x40000000, s23
    v_mov_b32 v11, v8
    v_mfma_f32_32x32x16_bf16 v[64:79], v[48:51], v[56:59], v[64:79]
    v_mfma_f32_32x32x16_bf16 v[80:95], v[52:55], v[56:59], v[80:95]
    v_mfma_f32_32x32x16_bf16 v[96:111], v[48:51], v[60:63], v[96:111]
    v_mfma_f32_32x32x16_bf16 v[112:127], v[52:55], v[60:63], v[112:127]
    s_nop 8
    v_cvt_pk_bf16_f32 v224, v64, v65
    v_cvt_pk_bf16_f32 v225, v66, v67
    v_cvt_pk_bf16_f32 v226, v68, v69
    v_cvt_pk_bf16_f32 v227, v70, v71
    v_cvt_pk_bf16_f32 v228, v72, v73
    v_cvt_pk_bf16_f32 v229, v74, v75
    v_cvt_pk_bf16_f32 v230, v76, v77
    v_cvt_pk_bf16_f32 v231, v78, v79
    v_cvt_pk_bf16_f32 v232, v80, v81
    v_cvt_pk_bf16_f32 v233, v82, v83
    v_cvt_pk_bf16_f32 v234, v84, v85
    v_cvt_pk_bf16_f32 v235, v86, v87
    v_cvt_pk_bf16_f32 v236, v88, v89
    v_cvt_pk_bf16_f32 v237, v90, v91
    v_cvt_pk_bf16_f32 v238, v92, v93
    v_cvt_pk_bf16_f32 v239, v94, v95
    v_cvt_pk_bf16_f32 v240, v96, v97
    v_cvt_pk_bf16_f32 v241, v98, v99
    v_cvt_pk_bf16_f32 v242, v100, v101
    v_cvt_pk_bf16_f32 v243, v102, v103
    v_cvt_pk_bf16_f32 v244, v104, v105
    v_cvt_pk_bf16_f32 v245, v106, v107
    v_cvt_pk_bf16_f32 v246, v108, v109
    v_cvt_pk_bf16_f32 v247, v110, v111
    v_cvt_pk_bf16_f32 v248, v112, v113
    v_cvt_pk_bf16_f32 v249, v114, v115
    v_cvt_pk_bf16_f32 v250, v116, v117
    v_cvt_pk_bf16_f32 v251, v118, v119
    v_cvt_pk_bf16_f32 v252, v120, v121
    v_cvt_pk_bf16_f32 v253, v122, v123
    v_cvt_pk_bf16_f32 v254, v124, v125
    v_cvt_pk_bf16_f32 v255, v126, v127
    s_barrier
    ds_read_b128 v[32:35], v9 offset:0
    ds_read_b128 v[36:39], v9 offset:1024
    ds_read_b128 v[40:43], v9 offset:2048
    ds_read_b128 v[44:47], v9 offset:3072
    ds_read_b128 v[48:51], v9 offset:8192
    ds_read_b128 v[52:55], v9 offset:9216
    s_waitcnt lgkmcnt(5)
    v_mfma_f32_32x32x16_bf16 v[128:143], v[192:195], v[32:35], 0
    ds_read_b128 v[56:59], v9 offset:10240
    s_waitcnt lgkmcnt(5)
    v_mfma_f32_32x32x16_bf16 v[128:143], v[196:199], v[36:39], v[128:143]
    ds_read_b128 v[60:63], v9 offset:11264
    s_waitcnt lgkmcnt(5)
    v_mfma_f32_32x32x16_bf16 v[128:143], v[200:203], v[40:43], v[128:143]
    ds_read_b128 v[32:35], v10 offset:0
    s_waitcnt lgkmcnt(5)
    v_mfma_f32_32x32x16_bf16 v[128:143], v[204:207], v[44:47], v[128:143]
    ds_read_b128 v[36:39], v10 offset:1024
    s_waitcnt lgkmcnt(5)
    v_mfma_f32_32x32x16_bf16 v[128:143], v[208:211], v[48:51], v[128:143]
    ds_read_b128 v[40:43], v10 offset:2048
    s_lshl_b32 s74, s68, 10
    v_add_u32 v12, s74, v8
    s_lshl_b32 s74, s68, 11
    s_add_u32 s74, s74, 0
    v_add_u32 v14, s74, v8
    v_and_b32 v13, 31, v0
    s_lshr_b32 s75, s68, 1
    s_lshl_b32 s75, s75, 5
    v_add_u32 v13, s75, v13
    v_mul_u32_u24 v13, 1792, v13
    s_lshl_b32 s76, s67, 7
    s_lshl_b32 s75, s65, 5
    s_add_u32 s76, s76, s75
    s_mul_i32 s75, s64, 448
    s_add_u32 s75, s75, s76
    s_and_b32 s74, s68, 1
    s_lshl_b32 s74, s74, 3
    s_add_u32 s75, s75, s74
    s_lshl_b32 s75, s75, 1
    s_cmp_ge_u32 s76, 448
    s_cselect_b32 s75, 0x40000000, s75
    v_lshrrev_b32 v15, 5, v0
    v_lshlrev_b32 v15, 5, v15
    v_add3_u32 v13, v13, v15, s75
    s_lshl_b32 s24, s71, 14
    s_add_u32 s24, s24, 2162688
    s_add_u32 s74, s65, 1
    s_and_b32 s74, s74, 3
    s_lshl_b32 s74, s74, 12
    s_add_u32 s27, s24, s74
    s_add_u32 s74, s65, 2
    s_and_b32 s74, s74, 3
    s_lshl_b32 s74, s74, 12
    s_add_u32 s28, s24, s74
    s_add_u32 s74, s65, 3
    s_and_b32 s74, s74, 3
    s_lshl_b32 s74, s74, 12
    s_add_u32 s29, s24, s74
    s_waitcnt lgkmcnt(5)
    v_mfma_f32_32x32x16_bf16 v[128:143], v[212:215], v[52:55], v[128:143]
    ds_read_b128 v[44:47], v10 offset:3072
    s_waitcnt lgkmcnt(5)
    v_mfma_f32_32x32x16_bf16 v[128:143], v[216:219], v[56:59], v[128:143]
    ds_read_b128 v[48:51], v10 offset:8192
    s_waitcnt lgkmcnt(5)
    v_mfma_f32_32x32x16_bf16 v[128:143], v[220:223], v[60:63], v[128:143]
    ds_read_b128 v[52:55], v10 offset:9216
    s_waitcnt lgkmcnt(5)
    v_mfma_f32_32x32x16_bf16 v[128:143], v[224:227], v[32:35], v[128:143]
    ds_read_b128 v[56:59], v10 offset:10240
    s_waitcnt lgkmcnt(5)
    v_mfma_f32_32x32x16_bf16 v[128:143], v[228:231], v[36:39], v[128:143]
    ds_read_b128 v[60:63], v10 offset:11264
    s_waitcnt lgkmcnt(5)
    v_mfma_f32_32x32x16_bf16 v[128:143], v[232:235], v[40:43], v[128:143]
    ds_read_b128 v[32:35], v9 offset:4096
    s_waitcnt lgkmcnt(5)
    v_mfma_f32_32x32x16_bf16 v[128:143], v[236:239], v[44:47], v[128:143]
    ds_read_b128 v[36:39], v9 offset:5120
    s_waitcnt lgkmcnt(5)
    v_mfma_f32_32x32x16_bf16 v[128:143], v[240:243], v[48:51], v[128:143]
    ds_read_b128 v[40:43], v9 offset:6144
    s_waitcnt lgkmcnt(5)
    v_mfma_f32_32x32x16_bf16 v[128:143], v[244:247], v[52:55], v[128:143]
    ds_read_b128 v[44:47], v9 offset:7168
    s_waitcnt lgkmcnt(5)
    v_mfma_f32_32x32x16_bf16 v[128:143], v[248:251], v[56:59], v[128:143]
    ds_read_b128 v[48:51], v9 offset:12288
    s_waitcnt lgkmcnt(5)
    v_mfma_f32_32x32x16_bf16 v[128:143], v[252:255], v[60:63], v[128:143]
    ds_read_b128 v[52:55], v9 offset:13312
    s_waitcnt lgkmcnt(5)
    v_mfma_f32_32x32x16_bf16 v[144:159], v[192:195], v[32:35], 0
    ds_read_b128 v[56:59], v9 offset:14336
    s_waitcnt lgkmcnt(5)
    v_mfma_f32_32x32x16_bf16 v[144:159], v[196:199], v[36:39], v[144:159]
    ds_read_b128 v[60:63], v9 offset:15360
    s_waitcnt lgkmcnt(5)
    v_mfma_f32_32x32x16_bf16 v[144:159], v[200:203], v[40:43], v[144:159]
    ds_read_b128 v[32:35], v10 offset:4096
    s_waitcnt lgkmcnt(5)
    v_mfma_f32_32x32x16_bf16 v[144:159], v[204:207], v[44:47], v[144:159]
    ds_read_b128 v[36:39], v10 offset:5120
    v_cvt_pk_bf16_f32 v160, v128, v129
    v_cvt_pk_bf16_f32 v161, v130, v131
    v_cvt_pk_bf16_f32 v162, v132, v133
    v_cvt_pk_bf16_f32 v163, v134, v135
    v_cvt_pk_bf16_f32 v164, v136, v137
    v_cvt_pk_bf16_f32 v165, v138, v139
    v_cvt_pk_bf16_f32 v166, v140, v141
    v_cvt_pk_bf16_f32 v167, v142, v143
    buffer_store_dwordx4 v[160:163], v8, s[52:55], s23 offen offset:0 sc1
    buffer_store_dwordx4 v[164:167], v8, s[52:55], s23 offen offset:1024 sc1
    s_cmp_eq_u32 s68, s65
    s_cbranch_scc0 L_ow_1
    ds_write_b128 v11, v[128:131] offset:0
    ds_write_b128 v11, v[132:135] offset:1024
    ds_write_b128 v11, v[136:139] offset:2048
    ds_write_b128 v11, v[140:143] offset:3072
L_ow_1:
    s_waitcnt lgkmcnt(5)
    v_mfma_f32_32x32x16_bf16 v[144:159], v[208:211], v[48:51], v[144:159]
    ds_read_b128 v[40:43], v10 offset:6144
    s_waitcnt lgkmcnt(5)
    v_mfma_f32_32x32x16_bf16 v[144:159], v[212:215], v[52:55], v[144:159]
    ds_read_b128 v[44:47], v10 offset:7168
    s_waitcnt lgkmcnt(5)
    v_mfma_f32_32x32x16_bf16 v[144:159], v[216:219], v[56:59], v[144:159]
    ds_read_b128 v[48:51], v10 offset:12288
    s_waitcnt lgkmcnt(5)
    v_mfma_f32_32x32x16_bf16 v[144:159], v[220:223], v[60:63], v[144:159]
    ds_read_b128 v[52:55], v10 offset:13312
    s_waitcnt lgkmcnt(5)
    v_mfma_f32_32x32x16_bf16 v[144:159], v[224:227], v[32:35], v[144:159]
    ds_read_b128 v[56:59], v10 offset:14336
    s_waitcnt lgkmcnt(5)
    v_mfma_f32_32x32x16_bf16 v[144:159], v[228:231], v[36:39], v[144:159]
    ds_read_b128 v[60:63], v10 offset:15360
    s_waitcnt lgkmcnt(5)
    v_mfma_f32_32x32x16_bf16 v[144:159], v[232:235], v[40:43], v[144:159]
    s_waitcnt lgkmcnt(4)
    v_mfma_f32_32x32x16_bf16 v[144:159], v[236:239], v[44:47], v[144:159]
    s_waitcnt lgkmcnt(3)
    v_mfma_f32_32x32x16_bf16 v[144:159], v[240:243], v[48:51], v[144:159]
    s_waitcnt lgkmcnt(2)
    v_mfma_f32_32x32x16_bf16 v[144:159], v[244:247], v[52:55], v[144:159]
    s_waitcnt lgkmcnt(1)
    v_mfma_f32_32x32x16_bf16 v[144:159], v[248:251], v[56:59], v[144:159]
    s_waitcnt lgkmcnt(0)
    v_mfma_f32_32x32x16_bf16 v[144:159], v[252:255], v[60:63], v[144:159]
    s_nop 11
    v_cvt_pk_bf16_f32 v168, v144, v145
    v_cvt_pk_bf16_f32 v169, v146, v147
    v_cvt_pk_bf16_f32 v170, v148, v149
    v_cvt_pk_bf16_f32 v171, v150, v151
    v_cvt_pk_bf16_f32 v172, v152, v153
    v_cvt_pk_bf16_f32 v173, v154, v155
    v_cvt_pk_bf16_f32 v174, v156, v157
    v_cvt_pk_bf16_f32 v175, v158, v159
    buffer_store_dwordx4 v[168:171], v8, s[52:55], s23 offen offset:2048 sc1
    buffer_store_dwordx4 v[172:175], v8, s[52:55], s23 offen offset:3072 sc1
    s_cmp_eq_u32 s68, s65
    s_cbranch_scc0 L_ow_2
    ds_write_b128 v11, v[144:147] offset:4096
    ds_write_b128 v11, v[148:151] offset:5120
    ds_write_b128 v11, v[152:155] offset:6144
    ds_write_b128 v11, v[156:159] offset:7168
L_ow_2:
    s_waitcnt lgkmcnt(0)
    s_barrier
    ds_read_b128 v[32:35], v14
    ds_read_b128 v[36:39], v14 offset:1024
    s_mov_b32 s79, 0x40000
L_x2_3:
    buffer_load_dwordx4 v[176:179], v12, s[52:55], s27 offen offset:0 sc1
    buffer_load_dwordx4 v[180:183], v12, s[52:55], s28 offen offset:0 sc1
    buffer_load_dwordx4 v[184:187], v12, s[52:55], s29 offen offset:0 sc1
    s_waitcnt vmcnt(0)
    v_max3_u32 v16, v176, v177, v178
    v_max3_u32 v16, v16, v179, v180
    v_max3_u32 v16, v16, v181, v182
    v_max3_u32 v16, v16, v183, v184
    v_max3_u32 v16, v16, v185, v186
    v_max_u32 v16, v16, v187
    v_cmp_eq_u32 vcc, -1, v16
    s_nop 4
    s_cbranch_vccz L_x2ok_4
    s_sub_u32 s79, s79, 1
    s_cbranch_scc0 L_x2_3
L_x2ok_4:
    s_waitcnt lgkmcnt(0)
    v_lshlrev_b32 v16, 16, v176
    v_and_b32 v17, 0xffff0000, v176
    v_add_f32 v32, v32, v16
    v_add_f32 v33, v33, v17
    v_lshlrev_b32 v16, 16, v177
    v_and_b32 v17, 0xffff0000, v177
    v_add_f32 v34, v34, v16
    v_add_f32 v35, v35, v17
    v_lshlrev_b32 v16, 16, v178
    v_and_b32 v17, 0xffff0000, v178
    v_add_f32 v36, v36, v16
    v_add_f32 v37, v37, v17
    v_lshlrev_b32 v16, 16, v179
    v_and_b32 v17, 0xffff0000, v179
    v_add_f32 v38, v38, v16
    v_add_f32 v39, v39, v17
    v_lshlrev_b32 v16, 16, v180
    v_and_b32 v17, 0xffff0000, v180
    v_add_f32 v32, v32, v16
    v_add_f32 v33, v33, v17
    v_lshlrev_b32 v16, 16, v181
    v_and_b32 v17, 0xffff0000, v181
    v_add_f32 v34, v34, v16
    v_add_f32 v35, v35, v17
    v_lshlrev_b32 v16, 16, v182
    v_and_b32 v17, 0xffff0000, v182
    v_add_f32 v36, v36, v16
    v_add_f32 v37, v37, v17
    v_lshlrev_b32 v16, 16, v183
    v_and_b32 v17, 0xffff0000, v183
    v_add_f32 v38, v38, v16
    v_add_f32 v39, v39, v17
    v_lshlrev_b32 v16, 16, v184
    v_and_b32 v17, 0xffff0000, v184
    v_add_f32 v32, v32, v16
    v_add_f32 v33, v33, v17
    v_lshlrev_b32 v16, 16, v185
    v_and_b32 v17, 0xffff0000, v185
    v_add_f32 v34, v34, v16
    v_add_f32 v35, v35, v17
    v_lshlrev_b32 v16, 16, v186
    v_and_b32 v17, 0xffff0000, v186
    v_add_f32 v36, v36, v16
    v_add_f32 v37, v37, v17
    v_lshlrev_b32 v16, 16, v187
    v_and_b32 v17, 0xffff0000, v187
    v_add_f32 v38, v38, v16
    v_add_f32 v39, v39, v17
    v_cvt_pk_bf16_f32 v40, v32, v33
    v_cvt_pk_bf16_f32 v41, v34, v35
    v_cvt_pk_bf16_f32 v42, v36, v37
    v_cvt_pk_bf16_f32 v43, v38, v39
    buffer_store_dwordx4 v[40:43], v13, s[56:59], 0 offen
    s_lshl_b32 s74, s70, 3
    s_add_u32 s74, s74, 2129920
    s_or_b32 s75, s69, s68
    s_cmp_eq_u32 s75, 0
    s_cselect_b32 s74, s74, 0x40000000
    v_mov_b32 v14, 0x40000000
    v_cmp_eq_u32 vcc, 0, v0
    s_nop 1
    v_cndmask_b32 v14, v14, 0, vcc
    v_mov_b32 v15, s21
    buffer_store_dword v15, v14, s[52:55], s74 offen sc1
    s_endpgm
.section .rodata,"a"
.p2align 6
.amdhsa_kernel concat_heads__gqa_block_cached__gqa_block_cached__near_ridge_kernel
  .amdhsa_next_free_vgpr 256
  .amdhsa_next_free_sgpr 102
  .amdhsa_accum_offset 256
  .amdhsa_group_segment_fixed_size 0
  .amdhsa_kernarg_size 104
  .amdhsa_user_sgpr_count 2
  .amdhsa_user_sgpr_kernarg_segment_ptr 1
  .amdhsa_system_sgpr_workgroup_id_x 1
.end_amdhsa_kernel
```
